```python
import torch

def _softmax(x, axis=-1):
    return torch.softmax(x, dim=axis)
def _gelu(x):
    return torch.nn.functional.gelu(x, approximate="tanh")
def _silu(x):
    return torch.nn.functional.silu(x)
def _sigmoid(x):
    return torch.sigmoid(x)
def _layernorm(x, axis=-1, eps=1e-5):
    m = x.mean(dim=axis, keepdim=True)
    v = x.var(dim=axis, keepdim=True, unbiased=False)
    return (x - m) / torch.sqrt(v + eps)
def _scatter_add(tgt, idx, src, axis=0):
    return tgt.clone().index_add_(axis, idx, src)
def _segment_sum(src, seg, n):
    out = torch.zeros((n,) + src.shape[1:], dtype=src.dtype)
    return out.index_add_(0, seg, src)
def _pad(x, pw):
    flat = tuple(v for pair in reversed(pw) for v in pair)
    return torch.nn.functional.pad(x, flat)

kernel_name = 'standalone__normalfloat_lut_codebook_lookup__prompt'

def setup_inputs():

    _w = (lambda a: (lambda t: t.to(torch.bfloat16) if t.is_floating_point() else t)(torch.as_tensor(a)))
    B, S, D, F = 1, 2048, 1024, 3584
    G = -1 if -1 > 0 else D
    D = (D // G) * G
    ng = D // G
    nf4 = torch.tensor([
        -1.0, -0.6961928009986877, -0.5250730514526367, -0.39491748809814453,
        -0.28444138169288635, -0.18477343022823334, -0.09105003625154495, 0.0,
        0.07958029955625534, 0.16093020141124725, 0.24611230194568634, 0.33791524171829224,
        0.44070982933044434, 0.5626170039176941, 0.7229568362236023, 1.0
    ], dtype=float)
    qw = torch.randint(0, 16, (D, F)).to(torch.int64)
    absmax = (torch.abs((lambda *s: torch.randn(*s, dtype=torch.bfloat16) * 0.05)(ng, F)) + 0.01).to(float)
    return {
        "x": _w((lambda *s: torch.randn(*s, dtype=torch.bfloat16) * 0.05)(B, S, D)),
        "qw": _w(qw),
        "codebook": _w(nf4),
        "absmax": _w(absmax),
    }

def reference(x, qw, codebook, absmax):
    B, S, D = x.shape
    ng, F = absmax.shape
    G = D // ng
    w_nf = codebook[qw]
    s = (lambda x, n, axis: torch.repeat_interleave(x, n, dim=axis))(absmax, G, axis=0)
    w = (lambda x, dt: x.to(dt))(w_nf * s, x.dtype)
    return torch.einsum("bsd,df->bsf", x, w)
```

```asm
; @launch grid=(256,1,1) block=(512,1,1) lds=160656
.amdgcn_target "amdgcn-amd-amdhsa--gfx950"
.text
.p2align 12
.globl standalone__normalfloat_lut_codebook_lookup__prompt_kernel
.p2align 8
.type standalone__normalfloat_lut_codebook_lookup__prompt_kernel,@function
standalone__normalfloat_lut_codebook_lookup__prompt_kernel:
    s_cmp_ge_u32 s2, 256
    s_cbranch_scc1 L_end
    s_load_dwordx2 s[4:5], s[0:1], 8
    s_load_dwordx2 s[8:9], s[0:1], 0
    s_load_dwordx2 s[12:13], s[0:1], 48
    s_load_dwordx2 s[56:57], s[0:1], 40
    s_load_dwordx2 s[20:21], s[0:1], 16
    s_load_dwordx2 s[24:25], s[0:1], 24
    s_load_dwordx2 s[16:17], s[0:1], 32
    v_lshrrev_b32 v3, 6, v0
    v_and_b32 v1, 63, v0
    s_and_b32 s44, s2, 7
    s_lshr_b32 s45, s2, 3
    v_readfirstlane_b32 s34, v3
    s_mov_b32 s6, 14680064
    s_mov_b32 s7, 0x20000
    s_mov_b32 s14, 1835008
    s_mov_b32 s15, 0x20000
    s_mov_b32 s58, 256
    s_mov_b32 s59, 0x20000
    s_getreg_b32 s55, hwreg(HW_REG_XCC_ID, 0, 4)
    s_lshr_b32 s37, s45, 1
    s_and_b32 s46, s45, 1
    s_lshl_b32 s38, s44, 1
    s_lshr_b32 s43, s37, 3
    s_add_u32 s43, s43, s38
    s_add_u32 s38, s38, s46
    s_lshl_b32 s54, s44, 5
    s_bfe_u32 s41, s37, 0x20001
    s_and_b32 s42, s37, 1
    s_cmp_eq_u32 s34, 5
    s_cbranch_scc1 L_xloader
    v_and_b32 v46, 31, v1
    v_lshrrev_b32 v48, 5, v1
    v_mul_u32_u24 v44, 917504, v48
    v_lshl_add_u32 v44, v46, 4, v44
    s_mov_b32 s82, 0x0fffffff
    s_mov_b32 s83, 0x0fffffff
    v_and_b32 v45, 3, v46
    v_lshlrev_b32 v45, 6, v45
    v_lshrrev_b32 v47, 2, v46
    v_cmp_eq_u32 vcc, 4, v47
    v_cmp_le_u32 s[50:51], 20, v46
    v_subrev_u32 v50, 20, v46
    v_cndmask_b32 v47, v47, 6, vcc
    v_lshl_add_u32 v45, v47, 10, v45
    v_cndmask_b32 v47, v46, v50, s[50:51]
    v_cndmask_b32 v49, 0, 4, s[50:51]
    v_cmp_gt_u32 vcc, 8, v47
    v_and_b32 v50, 1, v47
    v_add_u32 v49, v49, v50
    v_lshrrev_b32 v50, 1, v47
    v_lshlrev_b32 v50, 6, v50
    v_lshl_add_u32 v49, v49, 10, v50
    v_cndmask_b32 v45, v45, v49, vcc
    v_lshl_add_u32 v45, v48, 5, v45
    s_lshl_b32 s50, s46, 2
    s_sub_u32 s40, s34, s50
    s_lshr_b32 s78, s34, 1
    s_or_b32 s78, s78, s46
    s_lshl_b32 s50, s46, 3
    s_add_u32 s50, s50, s34
    s_bitcmp0_b32 49155, s50
    s_waitcnt lgkmcnt(0)
    s_load_dwordx8 s[60:67], s[20:21], 0
    s_cbranch_scc1 L_noissue
    s_call_b64 s[84:85], L_issue
    s_call_b64 s[84:85], L_issue_b
L_noissue:
    s_cmp_ge_u32 s34, 4
    s_cbranch_scc1 L_helpers
    s_branch L_cpro
L_issue:
    s_lshl_b32 s80, s40, 4
    s_add_u32 s80, s80, s41
    s_mul_i32 s80, s80, 114688
    s_lshl_b32 s81, s43, 1
    s_add_u32 s81, s81, s42
    s_mul_i32 s81, s81, 448
    s_add_u32 s80, s80, s81
    s_movk_i32 s81, 14336
    s_mov_b64 exec, s[82:83]
    buffer_load_dwordx4 v[60:63], v44, s[4:7], s80 offen
    s_add_u32 s80, s80, s81
    buffer_load_dwordx4 v[64:67], v44, s[4:7], s80 offen
    s_add_u32 s80, s80, s81
    buffer_load_dwordx4 v[68:71], v44, s[4:7], s80 offen
    s_add_u32 s80, s80, s81
    buffer_load_dwordx4 v[72:75], v44, s[4:7], s80 offen
    s_add_u32 s80, s80, s81
    buffer_load_dwordx4 v[76:79], v44, s[4:7], s80 offen
    s_add_u32 s80, s80, s81
    buffer_load_dwordx4 v[80:83], v44, s[4:7], s80 offen
    s_add_u32 s80, s80, s81
    buffer_load_dwordx4 v[84:87], v44, s[4:7], s80 offen
    s_add_u32 s80, s80, s81
    buffer_load_dwordx4 v[88:91], v44, s[4:7], s80 offen
    s_add_u32 s80, s80, 358400
    s_mov_b64 exec, -1
    s_setpc_b64 s[84:85]
L_issue_b:
    s_mov_b64 exec, s[82:83]
    buffer_load_dwordx4 v[92:95], v44, s[4:7], s80 offen
    s_add_u32 s80, s80, s81
    buffer_load_dwordx4 v[96:99], v44, s[4:7], s80 offen
    s_add_u32 s80, s80, s81
    buffer_load_dwordx4 v[100:103], v44, s[4:7], s80 offen
    s_add_u32 s80, s80, s81
    buffer_load_dwordx4 v[104:107], v44, s[4:7], s80 offen
    s_add_u32 s80, s80, s81
    buffer_load_dwordx4 v[108:111], v44, s[4:7], s80 offen
    s_add_u32 s80, s80, s81
    buffer_load_dwordx4 v[112:115], v44, s[4:7], s80 offen
    s_add_u32 s80, s80, s81
    buffer_load_dwordx4 v[116:119], v44, s[4:7], s80 offen
    s_add_u32 s80, s80, s81
    buffer_load_dwordx4 v[120:123], v44, s[4:7], s80 offen
    s_lshl_b32 s80, s43, 3
    s_add_u32 s80, s80, s40
    s_mul_i32 s80, s80, 14336
    s_mul_i32 s81, s42, 7168
    s_add_u32 s80, s80, s81
    s_lshl_b32 s81, s41, 8
    s_add_u32 s80, s80, s81
    buffer_load_dword v51, v45, s[12:15], s80 offen sc1
    s_mov_b64 exec, -1
    s_setpc_b64 s[84:85]
L_xloader:
    s_mov_b32 s10, 4194304
    s_mov_b32 s11, 0x20000
    s_mov_b32 s18, 14680064
    s_mov_b32 s19, 0x20000
    v_lshrrev_b32 v13, 3, v1
    v_and_b32 v14, 7, v1
    v_lshrrev_b32 v15, 4, v1
    v_xor_b32 v14, v14, v15
    v_lshlrev_b32 v14, 4, v14
    v_lshl_add_u32 v20, v13, 11, v14
    v_xor_b32 v21, 64, v20
    v_add_u32 v21, 15360, v21
    v_add_u32 v22, 30720, v20
    v_add_u32 v23, 30720, v21
    v_add_u32 v24, 65536, v20
    v_add_u32 v25, 65536, v21
    v_add_u32 v26, 96256, v20
    v_add_u32 v27, 96256, v21
    v_add_u32 v28, 131072, v20
    v_add_u32 v29, 131072, v21
    v_add_u32 v30, 161792, v20
    v_add_u32 v31, 161792, v21
    v_add_u32 v32, 196608, v20
    v_add_u32 v33, 196608, v21
    v_add_u32 v34, 227328, v20
    v_add_u32 v35, 227328, v21
    s_setprio 1
    s_lshl_b32 s48, s37, 18
    s_mov_b32 s49, 65536
    s_mov_b32 s50, s48
    s_mov_b32 s51, 73728
    v_mov_b32 v40, 159748
    v_mov_b32 v41, 1
    s_waitcnt lgkmcnt(0)
    s_cmp_eq_u32 s46, 1
    s_cbranch_scc1 L_x_up
    s_barrier
    s_call_b64 s[84:85], L_lda
    s_call_b64 s[84:85], L_ldb
    s_call_b64 s[84:85], L_lda
    s_call_b64 s[84:85], L_ldb
    s_branch L_x_j
L_x_up:
    s_call_b64 s[84:85], L_lda
    s_call_b64 s[84:85], L_ldb
    s_call_b64 s[84:85], L_lda
    s_call_b64 s[84:85], L_ldb
    s_barrier
L_x_j:
    s_waitcnt vmcnt(16)
    ds_write_b32 v40, v41
    s_waitcnt vmcnt(0)
    s_barrier
    s_call_b64 s[84:85], L_lda
    s_call_b64 s[84:85], L_ldb
    s_call_b64 s[84:85], L_lda
    s_call_b64 s[84:85], L_ldb
    s_waitcnt vmcnt(16)
    s_barrier
    s_call_b64 s[84:85], L_lda
    s_call_b64 s[84:85], L_ldb
    s_call_b64 s[84:85], L_lda
    s_waitcnt vmcnt(24)
    s_barrier
    s_mov_b32 s36, 3
L_xloop:
    s_call_b64 s[84:85], L_ldb
    s_call_b64 s[84:85], L_lda
    s_add_u32 s36, s36, 1
    s_cmp_lt_u32 s36, 13
    s_waitcnt vmcnt(24)
    s_barrier
    s_cbranch_scc1 L_xloop
    s_call_b64 s[84:85], L_ldb
    s_branch L_h_tail
L_lda:
    s_add_u32 m0, s49, 0
    s_nop 0
    buffer_load_dwordx4 v20, s[8:11], s48 offen offset:0  lds
    buffer_load_dwordx4 v21, s[8:11], s48 offen offset:1024  lds
    buffer_load_dwordx4 v22, s[8:11], s48 offen offset:2048  lds
    buffer_load_dwordx4 v23, s[8:11], s48 offen offset:3072  lds
    s_add_u32 m0, s49, 4096
    s_nop 0
    buffer_load_dwordx4 v24, s[8:11], s48 offen offset:0  lds
    buffer_load_dwordx4 v25, s[8:11], s48 offen offset:1024  lds
    buffer_load_dwordx4 v26, s[8:11], s48 offen offset:2048  lds
    buffer_load_dwordx4 v27, s[8:11], s48 offen offset:3072  lds
    s_add_u32 s48, s48, 128
    s_add_u32 s49, s49, 16384
    s_and_b32 s49, s49, 0xffff
    s_or_b32 s49, s49, 65536
    s_setpc_b64 s[84:85]
L_ldb:
    s_add_u32 m0, s51, 0
    s_nop 0
    buffer_load_dwordx4 v28, s[8:11], s50 offen offset:0  lds
    buffer_load_dwordx4 v29, s[8:11], s50 offen offset:1024  lds
    buffer_load_dwordx4 v30, s[8:11], s50 offen offset:2048  lds
    buffer_load_dwordx4 v31, s[8:11], s50 offen offset:3072  lds
    s_add_u32 m0, s51, 4096
    s_nop 0
    buffer_load_dwordx4 v32, s[8:11], s50 offen offset:0  lds
    buffer_load_dwordx4 v33, s[8:11], s50 offen offset:1024  lds
    buffer_load_dwordx4 v34, s[8:11], s50 offen offset:2048  lds
    buffer_load_dwordx4 v35, s[8:11], s50 offen offset:3072  lds
    s_add_u32 s50, s50, 128
    s_add_u32 s51, s51, 16384
    s_and_b32 s51, s51, 0xffff
    s_or_b32 s51, s51, 65536
    s_setpc_b64 s[84:85]
L_cpro:
    s_setprio 3
    s_mov_b32 s28, 0x0c0c0400
    s_mov_b32 s29, 0x0c0c0500
    s_mov_b32 s30, 0x0c0c0600
    s_mov_b32 s31, 0x0c0c0700
    s_and_b32 s35, s34, 1
    s_lshr_b32 s39, s34, 1
    v_and_b32 v13, 31, v1
    v_lshlrev_b32 v2, 2, v13
    v_and_b32 v13, 15, v1
    v_bfe_u32 v14, v13, 1, 3
    v_lshrrev_b32 v15, 4, v1
    v_xor_b32 v14, v14, v15
    v_lshlrev_b32 v14, 4, v14
    v_lshl_add_u32 v14, v13, 7, v14
    s_lshl_b32 s50, s35, 11
    s_add_u32 s50, s50, 65536
    v_add_u32 v4, s50, v14
    v_xor_b32 v5, 2048, v4
    v_xor_b32 v6, 64, v4
    v_xor_b32 v7, 64, v5
    s_mul_i32 s50, s39, 7168
    v_lshlrev_b32 v10, 4, v1
    s_mul_i32 s33, s38, 114688
    s_add_u32 s33, s33, s50
    s_add_u32 s50, s50, 131072
    v_add_u32 v9, s50, v10
    s_lshl_b32 s51, s35, 12
    v_add_u32 v8, s51, v9
    s_add_u32 s32, s33, s51
    v_and_b32 v11, 1, v1
    v_lshlrev_b32 v11, 2, v11
    s_lshl_b32 s47, s46, 3
    s_add_u32 s47, s47, s54
    s_or_b32 s48, s55, 0x10
    s_mul_i32 s48, s48, 0x01010101
    s_mov_b32 s49, 0x1f1f1f1f
    v_mov_b32 v12, 159744
    v_mul_u32_u24 v13, 464, v13
    v_lshl_add_u32 v16, v15, 4, v13
    v_lshl_add_u32 v17, v15, 3, v13
    s_mul_i32 s50, s39, 224
    s_add_u32 s50, s50, 32768
    s_mul_i32 s51, s35, 7424
    s_sub_u32 s52, 7424, s51
    s_add_u32 s51, s51, s50
    s_add_u32 s52, s52, s50
    s_mul_i32 s53, s35, 160
    v_add_u32 v16, s53, v16
    v_add_u32 v20, s51, v16
    v_add_u32 v21, s52, v16
    v_add_u32 v24, s51, v17
    s_lshl_b32 s50, s35, 6
    v_add_u32 v17, s50, v17
    v_add_u32 v22, s51, v17
    v_add_u32 v23, s52, v17
    s_mul_i32 s51, s39, 448
    s_add_u32 s51, s51, 159760
    v_lshl_add_u32 v27, v15, 4, s51
    s_lshl_b32 s50, s50, 1
    v_add_u32 v26, s50, v27
    s_lshl_b32 s53, s53, 1
    s_add_u32 s51, s51, s53
    v_lshl_add_u32 v25, v15, 5, s51
    v_mov_b64 v[140:141], 0
    v_mov_b64 v[142:143], 0
    v_mov_b64 v[144:145], 0
    v_mov_b64 v[146:147], 0
    v_mov_b64 v[148:149], 0
    v_mov_b64 v[150:151], 0
    v_mov_b64 v[152:153], 0
    v_mov_b64 v[154:155], 0
    v_mov_b64 v[156:157], 0
    v_mov_b64 v[158:159], 0
    v_mov_b64 v[160:161], 0
    v_mov_b64 v[162:163], 0
    v_mov_b64 v[164:165], 0
    v_mov_b64 v[166:167], 0
    v_mov_b64 v[168:169], 0
    v_mov_b64 v[170:171], 0
    v_mov_b64 v[172:173], 0
    v_mov_b64 v[174:175], 0
    v_mov_b64 v[176:177], 0
    v_mov_b64 v[178:179], 0
    v_mov_b64 v[180:181], 0
    v_mov_b64 v[182:183], 0
    v_mov_b64 v[184:185], 0
    v_mov_b64 v[186:187], 0
    v_mov_b64 v[188:189], 0
    v_mov_b64 v[190:191], 0
    v_mov_b64 v[192:193], 0
    v_mov_b64 v[194:195], 0
    v_mov_b64 v[196:197], 0
    v_mov_b64 v[198:199], 0
    v_mov_b64 v[200:201], 0
    v_mov_b64 v[202:203], 0
    v_mov_b64 v[204:205], 0
    v_mov_b64 v[206:207], 0
    v_mov_b64 v[208:209], 0
    v_mov_b64 v[210:211], 0
    v_mov_b64 v[212:213], 0
    v_mov_b64 v[214:215], 0
    v_mov_b64 v[216:217], 0
    v_mov_b64 v[218:219], 0
    v_mov_b64 v[220:221], 0
    v_mov_b64 v[222:223], 0
    v_mov_b64 v[224:225], 0
    v_mov_b64 v[226:227], 0
    v_mov_b64 v[228:229], 0
    v_mov_b64 v[230:231], 0
    v_mov_b64 v[232:233], 0
    v_mov_b64 v[234:235], 0
    v_mov_b64 v[236:237], 0
    v_mov_b64 v[238:239], 0
    v_mov_b64 v[240:241], 0
    v_mov_b64 v[242:243], 0
    v_mov_b64 v[244:245], 0
    v_mov_b64 v[246:247], 0
    v_mov_b64 v[248:249], 0
    v_mov_b64 v[250:251], 0
    s_cmp_lg_u32 s78, 0
    s_cbranch_scc1 L_c_nopack
    s_call_b64 s[84:85], L_pack
    s_call_b64 s[84:85], L_pack_b
    s_call_b64 s[84:85], L_store
    s_add_u32 s50, s37, s54
    v_mov_b32 v13, s50
    v_mov_b32 v14, s48
    s_cmp_lg_u32 s34, 0
    s_waitcnt vmcnt(0)
    s_cbranch_scc1 L_c_nopack
    s_mov_b64 exec, 1
    buffer_store_byte v14, v13, s[56:59], 0 offen
    s_mov_b64 exec, -1
L_c_nopack:
    s_barrier
    s_branch L_cstart
L_pack:
    s_waitcnt vmcnt(9)
    v_lshl_or_b32 v52, v64, 4, v60
    v_lshl_or_b32 v56, v65, 4, v61
    v_lshl_or_b32 v54, v66, 4, v62
    v_lshl_or_b32 v58, v67, 4, v63
    v_lshl_or_b32 v52, v68, 8, v52
    v_lshl_or_b32 v56, v69, 8, v56
    v_lshl_or_b32 v54, v70, 8, v54
    v_lshl_or_b32 v58, v71, 8, v58
    v_lshl_or_b32 v52, v72, 12, v52
    v_lshl_or_b32 v56, v73, 12, v56
    v_lshl_or_b32 v54, v74, 12, v54
    v_lshl_or_b32 v58, v75, 12, v58
    v_lshl_or_b32 v52, v76, 16, v52
    v_lshl_or_b32 v56, v77, 16, v56
    v_lshl_or_b32 v54, v78, 16, v54
    v_lshl_or_b32 v58, v79, 16, v58
    v_lshl_or_b32 v52, v80, 20, v52
    v_lshl_or_b32 v56, v81, 20, v56
    v_lshl_or_b32 v54, v82, 20, v54
    v_lshl_or_b32 v58, v83, 20, v58
    v_lshl_or_b32 v52, v84, 24, v52
    v_lshl_or_b32 v56, v85, 24, v56
    v_lshl_or_b32 v54, v86, 24, v54
    v_lshl_or_b32 v58, v87, 24, v58
    v_lshl_or_b32 v52, v88, 28, v52
    v_lshl_or_b32 v56, v89, 28, v56
    v_lshl_or_b32 v54, v90, 28, v54
    v_lshl_or_b32 v58, v91, 28, v58
    s_setpc_b64 s[84:85]
L_pack_b:
    s_waitcnt vmcnt(1)
    v_lshl_or_b32 v53, v96, 4, v92
    v_lshl_or_b32 v57, v97, 4, v93
    v_lshl_or_b32 v55, v98, 4, v94
    v_lshl_or_b32 v59, v99, 4, v95
    v_lshl_or_b32 v53, v100, 8, v53
    v_lshl_or_b32 v57, v101, 8, v57
    v_lshl_or_b32 v55, v102, 8, v55
    v_lshl_or_b32 v59, v103, 8, v59
    v_lshl_or_b32 v53, v104, 12, v53
    v_lshl_or_b32 v57, v105, 12, v57
    v_lshl_or_b32 v55, v106, 12, v55
    v_lshl_or_b32 v59, v107, 12, v59
    v_lshl_or_b32 v53, v108, 16, v53
    v_lshl_or_b32 v57, v109, 16, v57
    v_lshl_or_b32 v55, v110, 16, v55
    v_lshl_or_b32 v59, v111, 16, v59
    v_lshl_or_b32 v53, v112, 20, v53
    v_lshl_or_b32 v57, v113, 20, v57
    v_lshl_or_b32 v55, v114, 20, v55
    v_lshl_or_b32 v59, v115, 20, v59
    v_lshl_or_b32 v53, v116, 24, v53
    v_lshl_or_b32 v57, v117, 24, v57
    v_lshl_or_b32 v55, v118, 24, v55
    v_lshl_or_b32 v59, v119, 24, v59
    v_lshl_or_b32 v53, v120, 28, v53
    v_lshl_or_b32 v57, v121, 28, v57
    v_lshl_or_b32 v55, v122, 28, v55
    v_lshl_or_b32 v59, v123, 28, v59
    s_nop 1
    v_permlane32_swap_b32 v52, v54
    v_permlane32_swap_b32 v53, v55
    v_permlane32_swap_b32 v56, v58
    v_permlane32_swap_b32 v57, v59
    s_waitcnt vmcnt(0)
    s_setpc_b64 s[84:85]
L_store:
    s_mov_b64 exec, s[82:83]
    buffer_store_dwordx4 v[52:55], v45, s[12:15], s80 offen
    buffer_store_dwordx4 v[56:59], v45, s[12:15], s80 offen offset:16
    s_mov_b64 exec, -1
    s_setpc_b64 s[84:85]
L_helpers:
    s_cmp_lg_u32 s34, 4
    s_cbranch_scc1 L_packers
L_ploader:
    s_mov_b32 s18, 14680064
    s_mov_b32 s19, 0x20000
    s_cmp_ge_u32 s45, 4
    s_cbranch_scc1 L_nopf
    s_bitcmp0_b32 s45, 0
    s_cbranch_scc1 L_nopf
    s_getpc_b64 s[28:29]
L_pc:
    s_add_u32 s28, s28, L_cstart-L_pc
    s_addc_u32 s29, s29, 0
    s_mov_b32 s30, L_code_end-L_cstart
    s_mov_b32 s31, 0x20000
    v_lshlrev_b32 v14, 7, v1
    s_lshl_b32 s51, s37, 13
    buffer_load_dword v17, v14, s[28:31], s51 offen
L_nopf:
    v_lshlrev_b32 v10, 4, v1
    v_and_b32 v11, 1, v1
    v_lshlrev_b32 v11, 2, v11
    v_mov_b32 v9, v11
    s_lshl_b32 s47, s46, 3
    s_add_u32 s47, s47, s54
    s_mul_i32 s33, s38, 114688
    s_add_u32 s33, s33, 14336
    s_mul_i32 s28, s55, 0x01010101
    s_mov_b32 s29, 0x10101010
    s_mov_b32 s36, 1
    s_mov_b32 s49, 145408
    s_setprio 2
    v_mov_b32 v14, 159744
    v_mov_b32 v15, 0
    ds_write_b32 v14, v15
    ds_write_b32 v14, v15 offset:4
    s_waitcnt lgkmcnt(0)
    buffer_load_dword v17, v9, s[56:59], s47 offen sc1
    s_barrier
    s_or_b32 s30, s28, 0x20202020
    s_mov_b32 s31, 0x2f2f2f2f
    s_mov_b32 s79, 1
    s_mov_b32 s53, 0
    s_mov_b32 s77, 1
L_poll:
    buffer_load_dword v14, v9, s[56:59], s47 offen sc1
L_poll_chk:
    s_add_u32 s53, s53, 1
    s_waitcnt vmcnt(0)
    v_and_b32 v14, s31, v14
    v_cmp_ne_u32 vcc, s30, v14
    s_cmp_lt_u32 s53, 100
    s_nop 3
    s_cbranch_vccz L_poll_go
    s_cbranch_scc1 L_poll
    s_branch L_selfpack
L_poll_go:
L_poll_ok:
    s_add_u32 m0, s49, 0
    s_add_u32 s48, s33, 0
    buffer_load_dwordx4 v10, s[12:15], s48 offen offset:0 sc1 lds
    buffer_load_dwordx4 v10, s[12:15], s48 offen offset:1024 sc1 lds
    buffer_load_dwordx4 v10, s[12:15], s48 offen offset:2048 sc1 lds
    buffer_load_dwordx4 v10, s[12:15], s48 offen offset:3072 sc1 lds
    s_add_u32 m0, s49, 4096
    s_add_u32 s48, s33, 4096
    buffer_load_dwordx4 v10, s[12:15], s48 offen offset:0 sc1 lds
    buffer_load_dwordx4 v10, s[12:15], s48 offen offset:1024 sc1 lds
    buffer_load_dwordx4 v10, s[12:15], s48 offen offset:2048 sc1 lds
    buffer_load_dwordx4 v10, s[12:15], s48 offen offset:3072 sc1 lds
    s_add_u32 m0, s49, 8192
    s_add_u32 s48, s33, 8192
    buffer_load_dwordx4 v10, s[12:15], s48 offen offset:0 sc1 lds
    buffer_load_dwordx4 v10, s[12:15], s48 offen offset:1024 sc1 lds
    buffer_load_dwordx4 v10, s[12:15], s48 offen offset:2048 sc1 lds
    buffer_load_dwordx4 v10, s[12:15], s48 offen offset:3072 sc1 lds
    s_add_u32 m0, s49, 12288
    s_add_u32 s48, s33, 12288
    buffer_load_dwordx4 v10, s[12:15], s48 offen offset:0 sc1 lds
    buffer_load_dwordx4 v10, s[12:15], s48 offen offset:1024 sc1 lds
    s_add_u32 s33, s33, 14336
    s_xor_b32 s49, s49, 14336
    s_add_u32 s36, s36, 1
    s_mov_b32 s53, 0
    s_lshl_b32 s48, s36, 1
    s_lshr_b32 s48, 0xfa40, s48
    s_and_b32 s48, s48, 3
    s_lshl_b32 s48, s29, s48
    s_or_b32 s30, s28, s48
    s_or_b32 s31, s48, 0x0f0f0f0f
    s_lshr_b32 s48, 0xac0, s36
    s_and_b32 s48, s48, 16
    v_add_u32 v9, s48, v11
    s_cmp_eq_u32 s77, 1
    s_cbranch_scc1 L_p_late
    s_barrier
    buffer_load_dword v14, v9, s[56:59], s47 offen sc1
    s_waitcnt vmcnt(1)
    s_branch L_p_j
L_p_late:
    s_mov_b32 s77, 0
    s_waitcnt vmcnt(0)
    buffer_load_dword v14, v9, s[56:59], s47 offen sc1
L_p_j:
    s_cmp_eq_u32 s36, 8
    s_cbranch_scc1 L_p_end
    s_cmp_eq_u32 s79, 0
    s_barrier
    s_cbranch_scc1 L_poll_ok
    s_waitcnt vmcnt(0)
    v_and_b32 v14, s31, v14
    v_cmp_ne_u32 vcc, s30, v14
    s_nop 4
    s_cbranch_vccz L_poll_ok
    buffer_load_dword v14, v9, s[56:59], s47 offen sc1
    s_waitcnt vmcnt(0)
    v_and_b32 v14, s31, v14
    v_cmp_ne_u32 vcc, s30, v14
    s_nop 4
    s_cbranch_vccz L_poll_ok
    s_mov_b32 s77, 1
    s_barrier
    s_branch L_poll
L_p_end:
    s_barrier
    s_waitcnt vmcnt(0)
L_h_tail:
    s_movk_i32 s44, 464
    s_movk_i32 s45, 7168
    s_sub_u32 s35, s34, 4
    s_mul_i32 s50, s35, 7424
    s_add_u32 s50, s50, 32768
    s_waitcnt vmcnt(16)
    s_barrier
    v_add_u32 v13, 0, v1
    v_mul_u32_u24 v14, 2341, v13
    v_lshrrev_b32 v14, 16, v14
    v_mul_u32_u24 v15, 28, v14
    v_sub_u32 v15, v13, v15
    v_lshlrev_b32 v15, 4, v15
    v_mad_u32_u24 v60, v14, s44, v15
    v_mad_u32_u24 v68, v14, s45, v15
    v_add_u32 v60, s50, v60
    v_add_u32 v13, 64, v1
    v_mul_u32_u24 v14, 2341, v13
    v_lshrrev_b32 v14, 16, v14
    v_mul_u32_u24 v15, 28, v14
    v_sub_u32 v15, v13, v15
    v_lshlrev_b32 v15, 4, v15
    v_mad_u32_u24 v61, v14, s44, v15
    v_mad_u32_u24 v69, v14, s45, v15
    v_add_u32 v61, s50, v61
    v_add_u32 v13, 128, v1
    v_mul_u32_u24 v14, 2341, v13
    v_lshrrev_b32 v14, 16, v14
    v_mul_u32_u24 v15, 28, v14
    v_sub_u32 v15, v13, v15
    v_lshlrev_b32 v15, 4, v15
    v_mad_u32_u24 v62, v14, s44, v15
    v_mad_u32_u24 v70, v14, s45, v15
    v_add_u32 v62, s50, v62
    v_add_u32 v13, 192, v1
    v_mul_u32_u24 v14, 2341, v13
    v_lshrrev_b32 v14, 16, v14
    v_mul_u32_u24 v15, 28, v14
    v_sub_u32 v15, v13, v15
    v_lshlrev_b32 v15, 4, v15
    v_mad_u32_u24 v63, v14, s44, v15
    v_mad_u32_u24 v71, v14, s45, v15
    v_add_u32 v63, s50, v63
    s_waitcnt vmcnt(0)
    s_barrier
    v_add_u32 v13, 256, v1
    v_mul_u32_u24 v14, 2341, v13
    v_lshrrev_b32 v14, 16, v14
    v_mul_u32_u24 v15, 28, v14
    v_sub_u32 v15, v13, v15
    v_lshlrev_b32 v15, 4, v15
    v_mad_u32_u24 v64, v14, s44, v15
    v_mad_u32_u24 v72, v14, s45, v15
    v_add_u32 v64, s50, v64
    v_add_u32 v13, 320, v1
    v_mul_u32_u24 v14, 2341, v13
    v_lshrrev_b32 v14, 16, v14
    v_mul_u32_u24 v15, 28, v14
    v_sub_u32 v15, v13, v15
    v_lshlrev_b32 v15, 4, v15
    v_mad_u32_u24 v65, v14, s44, v15
    v_mad_u32_u24 v73, v14, s45, v15
    v_add_u32 v65, s50, v65
    v_add_u32 v13, 384, v1
    v_mul_u32_u24 v14, 2341, v13
    v_lshrrev_b32 v14, 16, v14
    v_mul_u32_u24 v15, 28, v14
    v_sub_u32 v15, v13, v15
    v_lshlrev_b32 v15, 4, v15
    v_mad_u32_u24 v66, v14, s44, v15
    v_mad_u32_u24 v74, v14, s45, v15
    v_add_u32 v66, s50, v66
    s_lshl_b32 s51, s37, 3
    s_add_u32 s51, s51, s35
    s_mul_i32 s51, s51, 114688
    s_mul_i32 s52, s38, 448
    s_add_u32 s51, s51, s52
    s_mov_b32 s36, 0
L_stloop:
    s_barrier
    ds_read_b128 v[80:83], v60 offset:32768
    ds_read_b128 v[84:87], v61 offset:32768
    ds_read_b128 v[88:91], v62 offset:32768
    ds_read_b128 v[92:95], v63 offset:32768
    ds_read_b128 v[96:99], v64 offset:32768
    ds_read_b128 v[100:103], v65 offset:32768
    ds_read_b128 v[104:107], v66 offset:32768
    s_waitcnt lgkmcnt(6)
    buffer_store_dwordx4 v[80:83], v68, s[16:19], s51 offen nt
    s_waitcnt lgkmcnt(5)
    buffer_store_dwordx4 v[84:87], v69, s[16:19], s51 offen nt
    s_waitcnt lgkmcnt(4)
    buffer_store_dwordx4 v[88:91], v70, s[16:19], s51 offen nt
    s_waitcnt lgkmcnt(3)
    buffer_store_dwordx4 v[92:95], v71, s[16:19], s51 offen nt
    s_waitcnt lgkmcnt(2)
    buffer_store_dwordx4 v[96:99], v72, s[16:19], s51 offen nt
    s_waitcnt lgkmcnt(1)
    buffer_store_dwordx4 v[100:103], v73, s[16:19], s51 offen nt
    s_waitcnt lgkmcnt(0)
    buffer_store_dwordx4 v[104:107], v74, s[16:19], s51 offen nt
    s_add_u32 s51, s51, 229376
    s_barrier
    ds_read_b128 v[108:111], v60 offset:47616
    ds_read_b128 v[112:115], v61 offset:47616
    ds_read_b128 v[116:119], v62 offset:47616
    ds_read_b128 v[120:123], v63 offset:47616
    ds_read_b128 v[124:127], v64 offset:47616
    ds_read_b128 v[128:131], v65 offset:47616
    ds_read_b128 v[132:135], v66 offset:47616
    s_waitcnt lgkmcnt(6)
    buffer_store_dwordx4 v[108:111], v68, s[16:19], s51 offen nt
    s_waitcnt lgkmcnt(5)
    buffer_store_dwordx4 v[112:115], v69, s[16:19], s51 offen nt
    s_waitcnt lgkmcnt(4)
    buffer_store_dwordx4 v[116:119], v70, s[16:19], s51 offen nt
    s_waitcnt lgkmcnt(3)
    buffer_store_dwordx4 v[120:123], v71, s[16:19], s51 offen nt
    s_waitcnt lgkmcnt(2)
    buffer_store_dwordx4 v[124:127], v72, s[16:19], s51 offen nt
    s_waitcnt lgkmcnt(1)
    buffer_store_dwordx4 v[128:131], v73, s[16:19], s51 offen nt
    s_waitcnt lgkmcnt(0)
    buffer_store_dwordx4 v[132:135], v74, s[16:19], s51 offen nt
    s_add_u32 s51, s51, 229376
    v_subrev_u32 v60, 32768, v60
    v_subrev_u32 v61, 32768, v61
    v_subrev_u32 v62, 32768, v62
    v_subrev_u32 v63, 32768, v63
    v_subrev_u32 v64, 32768, v64
    v_subrev_u32 v65, 32768, v65
    v_subrev_u32 v66, 32768, v66
    s_add_u32 s36, s36, 1
    s_cmp_lt_u32 s36, 2
    s_cbranch_scc1 L_stloop
L_end:
    s_endpgm
    .p2align 6
L_cstart:
L_cpoll:
    buffer_load_dword v14, v11, s[56:59], s47 offen sc1
    ds_read_b32 v15, v12
    s_waitcnt vmcnt(0) lgkmcnt(0)
    v_and_b32 v14, s49, v14
    v_cmp_ne_u32 vcc, s48, v14
    v_cmp_eq_u32 s[50:51], 0, v15
    s_nop 3
    s_cbranch_vccz L_cpoll_ok
    s_cmp_lg_u32 s50, 0
    s_cbranch_scc1 L_cpoll
L_cpoll_ok:
    buffer_load_dwordx4 v[136:139], v10, s[12:15], s33 offen offset:3072 sc1
    buffer_load_dwordx4 v[124:127], v10, s[12:15], s32 offen offset:0 sc1
    buffer_load_dwordx4 v[128:131], v10, s[12:15], s32 offen offset:1024 sc1
    buffer_load_dwordx4 v[132:135], v10, s[12:15], s32 offen offset:2048 sc1
L_xpoll:
    ds_read_b32 v15, v12 offset:4
    s_waitcnt lgkmcnt(0)
    v_cmp_eq_u32 vcc, 0, v15
    s_nop 4
    s_cbranch_vccnz L_xpoll
    ds_read_b128 v[60:63], v4 offset:0
    ds_read_b128 v[92:95], v6 offset:0
    ds_read_b128 v[64:67], v4 offset:4096
    ds_read_b128 v[96:99], v6 offset:4096
    ds_read_b128 v[68:71], v4 offset:8192
    ds_read_b128 v[100:103], v6 offset:8192
    ds_read_b128 v[72:75], v4 offset:12288
    ds_read_b128 v[104:107], v6 offset:12288
    ds_read_b128 v[76:79], v5 offset:0
    ds_read_b128 v[108:111], v7 offset:0
    ds_read_b128 v[80:83], v5 offset:4096
    ds_read_b128 v[112:115], v7 offset:4096
    ds_read_b128 v[84:87], v5 offset:8192
    ds_read_b128 v[116:119], v7 offset:8192
    ds_read_b128 v[88:91], v5 offset:12288
    ds_read_b128 v[120:123], v7 offset:12288
    s_waitcnt vmcnt(3)
    v_perm_b32 v12, v136, v2, s28
    v_perm_b32 v13, v136, v2, s29
    v_perm_b32 v14, v136, v2, s30
    v_perm_b32 v15, v136, v2, s31
    v_perm_b32 v16, v137, v2, s28
    v_perm_b32 v17, v137, v2, s29
    v_perm_b32 v18, v137, v2, s30
    v_perm_b32 v19, v137, v2, s31
    ds_read_b32 v52, v12
    ds_read_b32 v53, v13
    ds_read_b32 v54, v14
    ds_read_b32 v55, v15
    ds_read_b32 v56, v16
    ds_read_b32 v57, v17
    ds_read_b32 v58, v18
    ds_read_b32 v59, v19
    s_waitcnt vmcnt(2)
    v_perm_b32 v12, v124, v2, s28
    v_perm_b32 v13, v124, v2, s29
    v_perm_b32 v14, v124, v2, s30
    v_perm_b32 v15, v124, v2, s31
    v_perm_b32 v16, v125, v2, s28
    v_perm_b32 v17, v125, v2, s29
    v_perm_b32 v18, v125, v2, s30
    v_perm_b32 v19, v125, v2, s31
    ds_read_b32 v28, v12
    ds_read_b32 v29, v13
    ds_read_b32 v30, v14
    ds_read_b32 v31, v15
    ds_read_b32 v32, v16
    ds_read_b32 v33, v17
    ds_read_b32 v34, v18
    ds_read_b32 v35, v19
    s_waitcnt vmcnt(0)
    s_mov_b32 s36, 0
    .p2align 6
L_loop:
    s_waitcnt lgkmcnt(8)
    v_mfma_f32_16x16x32_bf16 v[152:155], v[52:55], v[60:63], v[152:155]
    v_perm_b32 v12, v128, v2, s28
    v_mfma_f32_16x16x32_bf16 v[152:155], v[56:59], v[92:95], v[152:155]
    v_perm_b32 v13, v128, v2, s29
    v_mfma_f32_16x16x32_bf16 v[168:171], v[52:55], v[64:67], v[168:171]
    ds_read_b32 v36, v12
    v_perm_b32 v14, v128, v2, s30
    v_mfma_f32_16x16x32_bf16 v[168:171], v[56:59], v[96:99], v[168:171]
    ds_read_b32 v37, v13
    v_perm_b32 v15, v128, v2, s31
    v_mfma_f32_16x16x32_bf16 v[184:187], v[52:55], v[68:71], v[184:187]
    ds_read_b32 v38, v14
    v_perm_b32 v16, v129, v2, s28
    v_mfma_f32_16x16x32_bf16 v[184:187], v[56:59], v[100:103], v[184:187]
    ds_read_b32 v39, v15
    v_perm_b32 v17, v129, v2, s29
    v_mfma_f32_16x16x32_bf16 v[200:203], v[52:55], v[72:75], v[200:203]
    ds_read_b32 v40, v16
    v_perm_b32 v18, v129, v2, s30
    v_mfma_f32_16x16x32_bf16 v[200:203], v[56:59], v[104:107], v[200:203]
    ds_read_b32 v41, v17
    v_perm_b32 v19, v129, v2, s31
    s_waitcnt lgkmcnt(6)
    v_mfma_f32_16x16x32_bf16 v[140:143], v[28:31], v[60:63], v[140:143]
    ds_read_b32 v42, v18
    v_perm_b32 v12, v132, v2, s28
    v_mfma_f32_16x16x32_bf16 v[140:143], v[32:35], v[92:95], v[140:143]
    ds_read_b32 v43, v19
    v_perm_b32 v13, v132, v2, s29
    v_mfma_f32_16x16x32_bf16 v[156:159], v[28:31], v[64:67], v[156:159]
    ds_read_b32 v44, v12
    v_perm_b32 v14, v132, v2, s30
    v_mfma_f32_16x16x32_bf16 v[156:159], v[32:35], v[96:99], v[156:159]
    ds_read_b32 v45, v13
    v_perm_b32 v15, v132, v2, s31
    v_mfma_f32_16x16x32_bf16 v[172:175], v[28:31], v[68:71], v[172:175]
    ds_read_b32 v46, v14
    v_perm_b32 v16, v133, v2, s28
    v_mfma_f32_16x16x32_bf16 v[172:175], v[32:35], v[100:103], v[172:175]
    ds_read_b32 v47, v15
    v_perm_b32 v17, v133, v2, s29
    v_mfma_f32_16x16x32_bf16 v[188:191], v[28:31], v[72:75], v[188:191]
    ds_read_b32 v48, v16
    v_perm_b32 v18, v133, v2, s30
    v_mfma_f32_16x16x32_bf16 v[188:191], v[32:35], v[104:107], v[188:191]
    ds_read_b32 v49, v17
    v_perm_b32 v19, v133, v2, s31
    v_mfma_f32_16x16x32_bf16 v[204:207], v[28:31], v[76:79], v[204:207]
    ds_read_b32 v50, v18
    v_perm_b32 v12, v138, v2, s28
    v_mfma_f32_16x16x32_bf16 v[204:207], v[32:35], v[108:111], v[204:207]
    ds_read_b32 v51, v19
    v_perm_b32 v13, v138, v2, s29
    v_mfma_f32_16x16x32_bf16 v[216:219], v[28:31], v[80:83], v[216:219]
    ds_read_b32 v52, v12
    v_perm_b32 v14, v138, v2, s30
    v_mfma_f32_16x16x32_bf16 v[216:219], v[32:35], v[112:115], v[216:219]
    ds_read_b32 v53, v13
    v_perm_b32 v15, v138, v2, s31
    v_mfma_f32_16x16x32_bf16 v[228:231], v[28:31], v[84:87], v[228:231]
    ds_read_b32 v54, v14
    v_perm_b32 v16, v139, v2, s28
    v_mfma_f32_16x16x32_bf16 v[228:231], v[32:35], v[116:119], v[228:231]
    ds_read_b32 v55, v15
    v_perm_b32 v17, v139, v2, s29
    v_mfma_f32_16x16x32_bf16 v[240:243], v[28:31], v[88:91], v[240:243]
    ds_read_b32 v56, v16
    v_perm_b32 v18, v139, v2, s30
    v_mfma_f32_16x16x32_bf16 v[240:243], v[32:35], v[120:123], v[240:243]
    ds_read_b32 v57, v17
    v_perm_b32 v19, v139, v2, s31
    s_waitcnt lgkmcnt(8)
    v_mfma_f32_16x16x32_bf16 v[144:147], v[36:39], v[60:63], v[144:147]
    ds_read_b32 v58, v18
    v_perm_b32 v12, v126, v2, s28
    v_mfma_f32_16x16x32_bf16 v[144:147], v[40:43], v[92:95], v[144:147]
    ds_read_b32 v59, v19
    v_perm_b32 v13, v126, v2, s29
    v_mfma_f32_16x16x32_bf16 v[160:163], v[36:39], v[64:67], v[160:163]
    ds_read_b32 v28, v12
    v_perm_b32 v14, v126, v2, s30
    v_mfma_f32_16x16x32_bf16 v[160:163], v[40:43], v[96:99], v[160:163]
    ds_read_b32 v29, v13
    v_perm_b32 v15, v126, v2, s31
    v_mfma_f32_16x16x32_bf16 v[176:179], v[36:39], v[68:71], v[176:179]
    ds_read_b32 v30, v14
    v_perm_b32 v16, v127, v2, s28
    v_mfma_f32_16x16x32_bf16 v[176:179], v[40:43], v[100:103], v[176:179]
    ds_read_b32 v31, v15
    v_perm_b32 v17, v127, v2, s29
    v_mfma_f32_16x16x32_bf16 v[192:195], v[36:39], v[72:75], v[192:195]
    ds_read_b32 v32, v16
    v_perm_b32 v18, v127, v2, s30
    v_mfma_f32_16x16x32_bf16 v[192:195], v[40:43], v[104:107], v[192:195]
    ds_read_b32 v33, v17
    v_perm_b32 v19, v127, v2, s31
    v_mfma_f32_16x16x32_bf16 v[208:211], v[36:39], v[76:79], v[208:211]
    ds_read_b32 v34, v18
    v_mfma_f32_16x16x32_bf16 v[208:211], v[40:43], v[108:111], v[208:211]
    ds_read_b32 v35, v19
    v_mfma_f32_16x16x32_bf16 v[220:223], v[36:39], v[80:83], v[220:223]
    s_barrier
    v_mfma_f32_16x16x32_bf16 v[220:223], v[40:43], v[112:115], v[220:223]
    ds_read_b128 v[136:139], v9 offset:17408
    v_mfma_f32_16x16x32_bf16 v[232:235], v[36:39], v[84:87], v[232:235]
    ds_read_b128 v[124:127], v8 offset:14336
    v_mfma_f32_16x16x32_bf16 v[232:235], v[40:43], v[116:119], v[232:235]
    v_mfma_f32_16x16x32_bf16 v[244:247], v[36:39], v[88:91], v[244:247]
    v_mfma_f32_16x16x32_bf16 v[244:247], v[40:43], v[120:123], v[244:247]
    s_waitcnt lgkmcnt(8)
    v_mfma_f32_16x16x32_bf16 v[148:151], v[44:47], v[60:63], v[148:151]
    ds_read_b128 v[60:63], v4 offset:16384
    v_mfma_f32_16x16x32_bf16 v[148:151], v[48:51], v[92:95], v[148:151]
    ds_read_b128 v[92:95], v6 offset:16384
    v_mfma_f32_16x16x32_bf16 v[164:167], v[44:47], v[64:67], v[164:167]
    ds_read_b128 v[64:67], v4 offset:20480
    v_mfma_f32_16x16x32_bf16 v[164:167], v[48:51], v[96:99], v[164:167]
    ds_read_b128 v[96:99], v6 offset:20480
    v_mfma_f32_16x16x32_bf16 v[180:183], v[44:47], v[68:71], v[180:183]
    ds_read_b128 v[68:71], v4 offset:24576
    v_mfma_f32_16x16x32_bf16 v[180:183], v[48:51], v[100:103], v[180:183]
    ds_read_b128 v[100:103], v6 offset:24576
    v_mfma_f32_16x16x32_bf16 v[196:199], v[44:47], v[72:75], v[196:199]
    ds_read_b128 v[72:75], v4 offset:28672
    v_mfma_f32_16x16x32_bf16 v[196:199], v[48:51], v[104:107], v[196:199]
    ds_read_b128 v[104:107], v6 offset:28672
    v_mfma_f32_16x16x32_bf16 v[212:215], v[44:47], v[76:79], v[212:215]
    ds_read_b128 v[76:79], v5 offset:16384
    v_mfma_f32_16x16x32_bf16 v[212:215], v[48:51], v[108:111], v[212:215]
    ds_read_b128 v[108:111], v7 offset:16384
    v_mfma_f32_16x16x32_bf16 v[224:227], v[44:47], v[80:83], v[224:227]
    ds_read_b128 v[80:83], v5 offset:20480
    v_mfma_f32_16x16x32_bf16 v[224:227], v[48:51], v[112:115], v[224:227]
    ds_read_b128 v[112:115], v7 offset:20480
    s_waitcnt lgkmcnt(8)
    v_mfma_f32_16x16x32_bf16 v[236:239], v[44:47], v[84:87], v[236:239]
    ds_read_b128 v[84:87], v5 offset:24576
    v_mfma_f32_16x16x32_bf16 v[236:239], v[48:51], v[116:119], v[236:239]
    ds_read_b128 v[116:119], v7 offset:24576
    v_mfma_f32_16x16x32_bf16 v[248:251], v[44:47], v[88:91], v[248:251]
    ds_read_b128 v[88:91], v5 offset:28672
    v_mfma_f32_16x16x32_bf16 v[248:251], v[48:51], v[120:123], v[248:251]
    ds_read_b128 v[120:123], v7 offset:28672
    s_waitcnt lgkmcnt(8)
    v_mfma_f32_16x16x32_bf16 v[152:155], v[52:55], v[60:63], v[152:155]
    v_perm_b32 v12, v130, v2, s28
    v_mfma_f32_16x16x32_bf16 v[152:155], v[56:59], v[92:95], v[152:155]
    v_perm_b32 v13, v130, v2, s29
    v_mfma_f32_16x16x32_bf16 v[168:171], v[52:55], v[64:67], v[168:171]
    ds_read_b32 v36, v12
    v_perm_b32 v14, v130, v2, s30
    v_mfma_f32_16x16x32_bf16 v[168:171], v[56:59], v[96:99], v[168:171]
    ds_read_b32 v37, v13
    v_perm_b32 v15, v130, v2, s31
    v_mfma_f32_16x16x32_bf16 v[184:187], v[52:55], v[68:71], v[184:187]
    ds_read_b32 v38, v14
    v_perm_b32 v16, v131, v2, s28
    v_mfma_f32_16x16x32_bf16 v[184:187], v[56:59], v[100:103], v[184:187]
    ds_read_b32 v39, v15
    v_perm_b32 v17, v131, v2, s29
    v_mfma_f32_16x16x32_bf16 v[200:203], v[52:55], v[72:75], v[200:203]
    ds_read_b32 v40, v16
    v_perm_b32 v18, v131, v2, s30
    v_mfma_f32_16x16x32_bf16 v[200:203], v[56:59], v[104:107], v[200:203]
    ds_read_b32 v41, v17
    v_perm_b32 v19, v131, v2, s31
    s_waitcnt lgkmcnt(6)
    v_mfma_f32_16x16x32_bf16 v[140:143], v[28:31], v[60:63], v[140:143]
    ds_read_b32 v42, v18
    v_perm_b32 v12, v134, v2, s28
    v_mfma_f32_16x16x32_bf16 v[140:143], v[32:35], v[92:95], v[140:143]
    ds_read_b32 v43, v19
    v_perm_b32 v13, v134, v2, s29
    v_mfma_f32_16x16x32_bf16 v[156:159], v[28:31], v[64:67], v[156:159]
    ds_read_b32 v44, v12
    v_perm_b32 v14, v134, v2, s30
    v_mfma_f32_16x16x32_bf16 v[156:159], v[32:35], v[96:99], v[156:159]
    ds_read_b32 v45, v13
    v_perm_b32 v15, v134, v2, s31
    v_mfma_f32_16x16x32_bf16 v[172:175], v[28:31], v[68:71], v[172:175]
    ds_read_b32 v46, v14
    v_perm_b32 v16, v135, v2, s28
    v_mfma_f32_16x16x32_bf16 v[172:175], v[32:35], v[100:103], v[172:175]
    ds_read_b32 v47, v15
    v_perm_b32 v17, v135, v2, s29
    v_mfma_f32_16x16x32_bf16 v[188:191], v[28:31], v[72:75], v[188:191]
    ds_read_b32 v48, v16
    v_perm_b32 v18, v135, v2, s30
    v_mfma_f32_16x16x32_bf16 v[188:191], v[32:35], v[104:107], v[188:191]
    ds_read_b32 v49, v17
    v_perm_b32 v19, v135, v2, s31
    v_mfma_f32_16x16x32_bf16 v[204:207], v[28:31], v[76:79], v[204:207]
    ds_read_b32 v50, v18
    v_perm_b32 v12, v136, v2, s28
    v_mfma_f32_16x16x32_bf16 v[204:207], v[32:35], v[108:111], v[204:207]
    ds_read_b32 v51, v19
    v_perm_b32 v13, v136, v2, s29
    v_mfma_f32_16x16x32_bf16 v[216:219], v[28:31], v[80:83], v[216:219]
    ds_read_b32 v52, v12
    v_perm_b32 v14, v136, v2, s30
    v_mfma_f32_16x16x32_bf16 v[216:219], v[32:35], v[112:115], v[216:219]
    ds_read_b32 v53, v13
    v_perm_b32 v15, v136, v2, s31
    v_mfma_f32_16x16x32_bf16 v[228:231], v[28:31], v[84:87], v[228:231]
    ds_read_b32 v54, v14
    v_perm_b32 v16, v137, v2, s28
    v_mfma_f32_16x16x32_bf16 v[228:231], v[32:35], v[116:119], v[228:231]
    ds_read_b32 v55, v15
    v_perm_b32 v17, v137, v2, s29
    v_mfma_f32_16x16x32_bf16 v[240:243], v[28:31], v[88:91], v[240:243]
    ds_read_b32 v56, v16
    v_perm_b32 v18, v137, v2, s30
    v_mfma_f32_16x16x32_bf16 v[240:243], v[32:35], v[120:123], v[240:243]
    ds_read_b32 v57, v17
    v_perm_b32 v19, v137, v2, s31
    s_waitcnt lgkmcnt(8)
    v_mfma_f32_16x16x32_bf16 v[144:147], v[36:39], v[60:63], v[144:147]
    ds_read_b32 v58, v18
    v_perm_b32 v12, v124, v2, s28
    v_mfma_f32_16x16x32_bf16 v[144:147], v[40:43], v[92:95], v[144:147]
    ds_read_b32 v59, v19
    v_perm_b32 v13, v124, v2, s29
    v_mfma_f32_16x16x32_bf16 v[160:163], v[36:39], v[64:67], v[160:163]
    ds_read_b32 v28, v12
    v_perm_b32 v14, v124, v2, s30
    v_mfma_f32_16x16x32_bf16 v[160:163], v[40:43], v[96:99], v[160:163]
    ds_read_b32 v29, v13
    v_perm_b32 v15, v124, v2, s31
    v_mfma_f32_16x16x32_bf16 v[176:179], v[36:39], v[68:71], v[176:179]
    ds_read_b32 v30, v14
    v_perm_b32 v16, v125, v2, s28
    v_mfma_f32_16x16x32_bf16 v[176:179], v[40:43], v[100:103], v[176:179]
    ds_read_b32 v31, v15
    v_perm_b32 v17, v125, v2, s29
    v_mfma_f32_16x16x32_bf16 v[192:195], v[36:39], v[72:75], v[192:195]
    ds_read_b32 v32, v16
    v_perm_b32 v18, v125, v2, s30
    v_mfma_f32_16x16x32_bf16 v[192:195], v[40:43], v[104:107], v[192:195]
    ds_read_b32 v33, v17
    v_perm_b32 v19, v125, v2, s31
    v_mfma_f32_16x16x32_bf16 v[208:211], v[36:39], v[76:79], v[208:211]
    ds_read_b32 v34, v18
    v_mfma_f32_16x16x32_bf16 v[208:211], v[40:43], v[108:111], v[208:211]
    ds_read_b32 v35, v19
    v_mfma_f32_16x16x32_bf16 v[220:223], v[36:39], v[80:83], v[220:223]
    s_barrier
    v_mfma_f32_16x16x32_bf16 v[220:223], v[40:43], v[112:115], v[220:223]
    ds_read_b128 v[128:131], v8 offset:15360
    v_mfma_f32_16x16x32_bf16 v[232:235], v[36:39], v[84:87], v[232:235]
    s_add_u32 s36, s36, 1
    ds_read_b128 v[132:135], v8 offset:16384
    v_mfma_f32_16x16x32_bf16 v[232:235], v[40:43], v[116:119], v[232:235]
    s_cmp_eq_u32 s36, 4
    v_mfma_f32_16x16x32_bf16 v[244:247], v[36:39], v[88:91], v[244:247]
    v_mfma_f32_16x16x32_bf16 v[244:247], v[40:43], v[120:123], v[244:247]
    s_waitcnt lgkmcnt(8)
    v_mfma_f32_16x16x32_bf16 v[148:151], v[44:47], v[60:63], v[148:151]
    ds_read_b128 v[60:63], v4 offset:32768
    v_mfma_f32_16x16x32_bf16 v[148:151], v[48:51], v[92:95], v[148:151]
    ds_read_b128 v[92:95], v6 offset:32768
    v_mfma_f32_16x16x32_bf16 v[164:167], v[44:47], v[64:67], v[164:167]
    ds_read_b128 v[64:67], v4 offset:36864
    v_mfma_f32_16x16x32_bf16 v[164:167], v[48:51], v[96:99], v[164:167]
    ds_read_b128 v[96:99], v6 offset:36864
    v_mfma_f32_16x16x32_bf16 v[180:183], v[44:47], v[68:71], v[180:183]
    ds_read_b128 v[68:71], v4 offset:40960
    v_mfma_f32_16x16x32_bf16 v[180:183], v[48:51], v[100:103], v[180:183]
    ds_read_b128 v[100:103], v6 offset:40960
    v_mfma_f32_16x16x32_bf16 v[196:199], v[44:47], v[72:75], v[196:199]
    ds_read_b128 v[72:75], v4 offset:45056
    v_mfma_f32_16x16x32_bf16 v[196:199], v[48:51], v[104:107], v[196:199]
    ds_read_b128 v[104:107], v6 offset:45056
    v_mfma_f32_16x16x32_bf16 v[212:215], v[44:47], v[76:79], v[212:215]
    ds_read_b128 v[76:79], v5 offset:32768
    v_mfma_f32_16x16x32_bf16 v[212:215], v[48:51], v[108:111], v[212:215]
    ds_read_b128 v[108:111], v7 offset:32768
    v_mfma_f32_16x16x32_bf16 v[224:227], v[44:47], v[80:83], v[224:227]
    ds_read_b128 v[80:83], v5 offset:36864
    v_mfma_f32_16x16x32_bf16 v[224:227], v[48:51], v[112:115], v[224:227]
    ds_read_b128 v[112:115], v7 offset:36864
    s_waitcnt lgkmcnt(8)
    v_mfma_f32_16x16x32_bf16 v[236:239], v[44:47], v[84:87], v[236:239]
    ds_read_b128 v[84:87], v5 offset:40960
    v_mfma_f32_16x16x32_bf16 v[236:239], v[48:51], v[116:119], v[236:239]
    ds_read_b128 v[116:119], v7 offset:40960
    v_mfma_f32_16x16x32_bf16 v[248:251], v[44:47], v[88:91], v[248:251]
    ds_read_b128 v[88:91], v5 offset:45056
    v_mfma_f32_16x16x32_bf16 v[248:251], v[48:51], v[120:123], v[248:251]
    ds_read_b128 v[120:123], v7 offset:45056
    s_cbranch_scc1 L_tail
    s_waitcnt lgkmcnt(8)
    v_mfma_f32_16x16x32_bf16 v[152:155], v[52:55], v[60:63], v[152:155]
    v_perm_b32 v12, v128, v2, s28
    v_mfma_f32_16x16x32_bf16 v[152:155], v[56:59], v[92:95], v[152:155]
    v_perm_b32 v13, v128, v2, s29
    v_mfma_f32_16x16x32_bf16 v[168:171], v[52:55], v[64:67], v[168:171]
    ds_read_b32 v36, v12
    v_perm_b32 v14, v128, v2, s30
    v_mfma_f32_16x16x32_bf16 v[168:171], v[56:59], v[96:99], v[168:171]
    ds_read_b32 v37, v13
    v_perm_b32 v15, v128, v2, s31
    v_mfma_f32_16x16x32_bf16 v[184:187], v[52:55], v[68:71], v[184:187]
    ds_read_b32 v38, v14
    v_perm_b32 v16, v129, v2, s28
    v_mfma_f32_16x16x32_bf16 v[184:187], v[56:59], v[100:103], v[184:187]
    ds_read_b32 v39, v15
    v_perm_b32 v17, v129, v2, s29
    v_mfma_f32_16x16x32_bf16 v[200:203], v[52:55], v[72:75], v[200:203]
    ds_read_b32 v40, v16
    v_perm_b32 v18, v129, v2, s30
    v_mfma_f32_16x16x32_bf16 v[200:203], v[56:59], v[104:107], v[200:203]
    ds_read_b32 v41, v17
    v_perm_b32 v19, v129, v2, s31
    s_waitcnt lgkmcnt(6)
    v_mfma_f32_16x16x32_bf16 v[140:143], v[28:31], v[60:63], v[140:143]
    ds_read_b32 v42, v18
    v_perm_b32 v12, v132, v2, s28
    v_mfma_f32_16x16x32_bf16 v[140:143], v[32:35], v[92:95], v[140:143]
    ds_read_b32 v43, v19
    v_perm_b32 v13, v132, v2, s29
    v_mfma_f32_16x16x32_bf16 v[156:159], v[28:31], v[64:67], v[156:159]
    ds_read_b32 v44, v12
    v_perm_b32 v14, v132, v2, s30
    v_mfma_f32_16x16x32_bf16 v[156:159], v[32:35], v[96:99], v[156:159]
    ds_read_b32 v45, v13
    v_perm_b32 v15, v132, v2, s31
    v_mfma_f32_16x16x32_bf16 v[172:175], v[28:31], v[68:71], v[172:175]
    ds_read_b32 v46, v14
    v_perm_b32 v16, v133, v2, s28
    v_mfma_f32_16x16x32_bf16 v[172:175], v[32:35], v[100:103], v[172:175]
    ds_read_b32 v47, v15
    v_perm_b32 v17, v133, v2, s29
    v_mfma_f32_16x16x32_bf16 v[188:191], v[28:31], v[72:75], v[188:191]
    ds_read_b32 v48, v16
    v_perm_b32 v18, v133, v2, s30
    v_mfma_f32_16x16x32_bf16 v[188:191], v[32:35], v[104:107], v[188:191]
    ds_read_b32 v49, v17
    v_perm_b32 v19, v133, v2, s31
    v_mfma_f32_16x16x32_bf16 v[204:207], v[28:31], v[76:79], v[204:207]
    ds_read_b32 v50, v18
    v_perm_b32 v12, v138, v2, s28
    v_mfma_f32_16x16x32_bf16 v[204:207], v[32:35], v[108:111], v[204:207]
    ds_read_b32 v51, v19
    v_perm_b32 v13, v138, v2, s29
    v_mfma_f32_16x16x32_bf16 v[216:219], v[28:31], v[80:83], v[216:219]
    ds_read_b32 v52, v12
    v_perm_b32 v14, v138, v2, s30
    v_mfma_f32_16x16x32_bf16 v[216:219], v[32:35], v[112:115], v[216:219]
    ds_read_b32 v53, v13
    v_perm_b32 v15, v138, v2, s31
    v_mfma_f32_16x16x32_bf16 v[228:231], v[28:31], v[84:87], v[228:231]
    ds_read_b32 v54, v14
    v_perm_b32 v16, v139, v2, s28
    v_mfma_f32_16x16x32_bf16 v[228:231], v[32:35], v[116:119], v[228:231]
    ds_read_b32 v55, v15
    v_perm_b32 v17, v139, v2, s29
    v_mfma_f32_16x16x32_bf16 v[240:243], v[28:31], v[88:91], v[240:243]
    ds_read_b32 v56, v16
    v_perm_b32 v18, v139, v2, s30
    v_mfma_f32_16x16x32_bf16 v[240:243], v[32:35], v[120:123], v[240:243]
    ds_read_b32 v57, v17
    v_perm_b32 v19, v139, v2, s31
    s_waitcnt lgkmcnt(8)
    v_mfma_f32_16x16x32_bf16 v[144:147], v[36:39], v[60:63], v[144:147]
    ds_read_b32 v58, v18
    v_perm_b32 v12, v126, v2, s28
    v_mfma_f32_16x16x32_bf16 v[144:147], v[40:43], v[92:95], v[144:147]
    ds_read_b32 v59, v19
    v_perm_b32 v13, v126, v2, s29
    v_mfma_f32_16x16x32_bf16 v[160:163], v[36:39], v[64:67], v[160:163]
    ds_read_b32 v28, v12
    v_perm_b32 v14, v126, v2, s30
    v_mfma_f32_16x16x32_bf16 v[160:163], v[40:43], v[96:99], v[160:163]
    ds_read_b32 v29, v13
    v_perm_b32 v15, v126, v2, s31
    v_mfma_f32_16x16x32_bf16 v[176:179], v[36:39], v[68:71], v[176:179]
    ds_read_b32 v30, v14
    v_perm_b32 v16, v127, v2, s28
    v_mfma_f32_16x16x32_bf16 v[176:179], v[40:43], v[100:103], v[176:179]
    ds_read_b32 v31, v15
    v_perm_b32 v17, v127, v2, s29
    v_mfma_f32_16x16x32_bf16 v[192:195], v[36:39], v[72:75], v[192:195]
    ds_read_b32 v32, v16
    v_perm_b32 v18, v127, v2, s30
    v_mfma_f32_16x16x32_bf16 v[192:195], v[40:43], v[104:107], v[192:195]
    ds_read_b32 v33, v17
    v_perm_b32 v19, v127, v2, s31
    v_mfma_f32_16x16x32_bf16 v[208:211], v[36:39], v[76:79], v[208:211]
    ds_read_b32 v34, v18
    v_mfma_f32_16x16x32_bf16 v[208:211], v[40:43], v[108:111], v[208:211]
    ds_read_b32 v35, v19
    v_mfma_f32_16x16x32_bf16 v[220:223], v[36:39], v[80:83], v[220:223]
    s_barrier
    v_mfma_f32_16x16x32_bf16 v[220:223], v[40:43], v[112:115], v[220:223]
    ds_read_b128 v[136:139], v9 offset:3072
    v_mfma_f32_16x16x32_bf16 v[232:235], v[36:39], v[84:87], v[232:235]
    ds_read_b128 v[124:127], v8 offset:0
    v_mfma_f32_16x16x32_bf16 v[232:235], v[40:43], v[116:119], v[232:235]
    v_mfma_f32_16x16x32_bf16 v[244:247], v[36:39], v[88:91], v[244:247]
    v_mfma_f32_16x16x32_bf16 v[244:247], v[40:43], v[120:123], v[244:247]
    s_waitcnt lgkmcnt(8)
    v_mfma_f32_16x16x32_bf16 v[148:151], v[44:47], v[60:63], v[148:151]
    ds_read_b128 v[60:63], v4 offset:49152
    v_mfma_f32_16x16x32_bf16 v[148:151], v[48:51], v[92:95], v[148:151]
    ds_read_b128 v[92:95], v6 offset:49152
    v_mfma_f32_16x16x32_bf16 v[164:167], v[44:47], v[64:67], v[164:167]
    ds_read_b128 v[64:67], v4 offset:53248
    v_mfma_f32_16x16x32_bf16 v[164:167], v[48:51], v[96:99], v[164:167]
    ds_read_b128 v[96:99], v6 offset:53248
    v_mfma_f32_16x16x32_bf16 v[180:183], v[44:47], v[68:71], v[180:183]
    ds_read_b128 v[68:71], v4 offset:57344
    v_mfma_f32_16x16x32_bf16 v[180:183], v[48:51], v[100:103], v[180:183]
    ds_read_b128 v[100:103], v6 offset:57344
    v_mfma_f32_16x16x32_bf16 v[196:199], v[44:47], v[72:75], v[196:199]
    ds_read_b128 v[72:75], v4 offset:61440
    v_mfma_f32_16x16x32_bf16 v[196:199], v[48:51], v[104:107], v[196:199]
    ds_read_b128 v[104:107], v6 offset:61440
    v_mfma_f32_16x16x32_bf16 v[212:215], v[44:47], v[76:79], v[212:215]
    ds_read_b128 v[76:79], v5 offset:49152
    v_mfma_f32_16x16x32_bf16 v[212:215], v[48:51], v[108:111], v[212:215]
    ds_read_b128 v[108:111], v7 offset:49152
    v_mfma_f32_16x16x32_bf16 v[224:227], v[44:47], v[80:83], v[224:227]
    ds_read_b128 v[80:83], v5 offset:53248
    v_mfma_f32_16x16x32_bf16 v[224:227], v[48:51], v[112:115], v[224:227]
    ds_read_b128 v[112:115], v7 offset:53248
    s_waitcnt lgkmcnt(8)
    v_mfma_f32_16x16x32_bf16 v[236:239], v[44:47], v[84:87], v[236:239]
    ds_read_b128 v[84:87], v5 offset:57344
    v_mfma_f32_16x16x32_bf16 v[236:239], v[48:51], v[116:119], v[236:239]
    ds_read_b128 v[116:119], v7 offset:57344
    v_mfma_f32_16x16x32_bf16 v[248:251], v[44:47], v[88:91], v[248:251]
    ds_read_b128 v[88:91], v5 offset:61440
    v_mfma_f32_16x16x32_bf16 v[248:251], v[48:51], v[120:123], v[248:251]
    ds_read_b128 v[120:123], v7 offset:61440
    s_waitcnt lgkmcnt(8)
    v_mfma_f32_16x16x32_bf16 v[152:155], v[52:55], v[60:63], v[152:155]
    v_perm_b32 v12, v130, v2, s28
    v_mfma_f32_16x16x32_bf16 v[152:155], v[56:59], v[92:95], v[152:155]
    v_perm_b32 v13, v130, v2, s29
    v_mfma_f32_16x16x32_bf16 v[168:171], v[52:55], v[64:67], v[168:171]
    ds_read_b32 v36, v12
    v_perm_b32 v14, v130, v2, s30
    v_mfma_f32_16x16x32_bf16 v[168:171], v[56:59], v[96:99], v[168:171]
    ds_read_b32 v37, v13
    v_perm_b32 v15, v130, v2, s31
    v_mfma_f32_16x16x32_bf16 v[184:187], v[52:55], v[68:71], v[184:187]
    ds_read_b32 v38, v14
    v_perm_b32 v16, v131, v2, s28
    v_mfma_f32_16x16x32_bf16 v[184:187], v[56:59], v[100:103], v[184:187]
    ds_read_b32 v39, v15
    v_perm_b32 v17, v131, v2, s29
    v_mfma_f32_16x16x32_bf16 v[200:203], v[52:55], v[72:75], v[200:203]
    ds_read_b32 v40, v16
    v_perm_b32 v18, v131, v2, s30
    v_mfma_f32_16x16x32_bf16 v[200:203], v[56:59], v[104:107], v[200:203]
    ds_read_b32 v41, v17
    v_perm_b32 v19, v131, v2, s31
    s_waitcnt lgkmcnt(6)
    v_mfma_f32_16x16x32_bf16 v[140:143], v[28:31], v[60:63], v[140:143]
    ds_read_b32 v42, v18
    v_perm_b32 v12, v134, v2, s28
    v_mfma_f32_16x16x32_bf16 v[140:143], v[32:35], v[92:95], v[140:143]
    ds_read_b32 v43, v19
    v_perm_b32 v13, v134, v2, s29
    v_mfma_f32_16x16x32_bf16 v[156:159], v[28:31], v[64:67], v[156:159]
    ds_read_b32 v44, v12
    v_perm_b32 v14, v134, v2, s30
    v_mfma_f32_16x16x32_bf16 v[156:159], v[32:35], v[96:99], v[156:159]
    ds_read_b32 v45, v13
    v_perm_b32 v15, v134, v2, s31
    v_mfma_f32_16x16x32_bf16 v[172:175], v[28:31], v[68:71], v[172:175]
    ds_read_b32 v46, v14
    v_perm_b32 v16, v135, v2, s28
    v_mfma_f32_16x16x32_bf16 v[172:175], v[32:35], v[100:103], v[172:175]
    ds_read_b32 v47, v15
    v_perm_b32 v17, v135, v2, s29
    v_mfma_f32_16x16x32_bf16 v[188:191], v[28:31], v[72:75], v[188:191]
    ds_read_b32 v48, v16
    v_perm_b32 v18, v135, v2, s30
    v_mfma_f32_16x16x32_bf16 v[188:191], v[32:35], v[104:107], v[188:191]
    ds_read_b32 v49, v17
    v_perm_b32 v19, v135, v2, s31
    v_mfma_f32_16x16x32_bf16 v[204:207], v[28:31], v[76:79], v[204:207]
    ds_read_b32 v50, v18
    v_perm_b32 v12, v136, v2, s28
    v_mfma_f32_16x16x32_bf16 v[204:207], v[32:35], v[108:111], v[204:207]
    ds_read_b32 v51, v19
    v_perm_b32 v13, v136, v2, s29
    v_mfma_f32_16x16x32_bf16 v[216:219], v[28:31], v[80:83], v[216:219]
    ds_read_b32 v52, v12
    v_perm_b32 v14, v136, v2, s30
    v_mfma_f32_16x16x32_bf16 v[216:219], v[32:35], v[112:115], v[216:219]
    ds_read_b32 v53, v13
    v_perm_b32 v15, v136, v2, s31
    v_mfma_f32_16x16x32_bf16 v[228:231], v[28:31], v[84:87], v[228:231]
    ds_read_b32 v54, v14
    v_perm_b32 v16, v137, v2, s28
    v_mfma_f32_16x16x32_bf16 v[228:231], v[32:35], v[116:119], v[228:231]
    ds_read_b32 v55, v15
    v_perm_b32 v17, v137, v2, s29
    v_mfma_f32_16x16x32_bf16 v[240:243], v[28:31], v[88:91], v[240:243]
    ds_read_b32 v56, v16
    v_perm_b32 v18, v137, v2, s30
    v_mfma_f32_16x16x32_bf16 v[240:243], v[32:35], v[120:123], v[240:243]
    ds_read_b32 v57, v17
    v_perm_b32 v19, v137, v2, s31
    s_waitcnt lgkmcnt(8)
    v_mfma_f32_16x16x32_bf16 v[144:147], v[36:39], v[60:63], v[144:147]
    ds_read_b32 v58, v18
    v_perm_b32 v12, v124, v2, s28
    v_mfma_f32_16x16x32_bf16 v[144:147], v[40:43], v[92:95], v[144:147]
    ds_read_b32 v59, v19
    v_perm_b32 v13, v124, v2, s29
    v_mfma_f32_16x16x32_bf16 v[160:163], v[36:39], v[64:67], v[160:163]
    ds_read_b32 v28, v12
    v_perm_b32 v14, v124, v2, s30
    v_mfma_f32_16x16x32_bf16 v[160:163], v[40:43], v[96:99], v[160:163]
    ds_read_b32 v29, v13
    v_perm_b32 v15, v124, v2, s31
    v_mfma_f32_16x16x32_bf16 v[176:179], v[36:39], v[68:71], v[176:179]
    ds_read_b32 v30, v14
    v_perm_b32 v16, v125, v2, s28
    v_mfma_f32_16x16x32_bf16 v[176:179], v[40:43], v[100:103], v[176:179]
    ds_read_b32 v31, v15
    v_perm_b32 v17, v125, v2, s29
    v_mfma_f32_16x16x32_bf16 v[192:195], v[36:39], v[72:75], v[192:195]
    ds_read_b32 v32, v16
    v_perm_b32 v18, v125, v2, s30
    v_mfma_f32_16x16x32_bf16 v[192:195], v[40:43], v[104:107], v[192:195]
    ds_read_b32 v33, v17
    v_perm_b32 v19, v125, v2, s31
    v_mfma_f32_16x16x32_bf16 v[208:211], v[36:39], v[76:79], v[208:211]
    ds_read_b32 v34, v18
    v_mfma_f32_16x16x32_bf16 v[208:211], v[40:43], v[108:111], v[208:211]
    ds_read_b32 v35, v19
    v_mfma_f32_16x16x32_bf16 v[220:223], v[36:39], v[80:83], v[220:223]
    s_barrier
    v_mfma_f32_16x16x32_bf16 v[220:223], v[40:43], v[112:115], v[220:223]
    ds_read_b128 v[128:131], v8 offset:1024
    v_mfma_f32_16x16x32_bf16 v[232:235], v[36:39], v[84:87], v[232:235]
    ds_read_b128 v[132:135], v8 offset:2048
    v_mfma_f32_16x16x32_bf16 v[232:235], v[40:43], v[116:119], v[232:235]
    v_mfma_f32_16x16x32_bf16 v[244:247], v[36:39], v[88:91], v[244:247]
    v_mfma_f32_16x16x32_bf16 v[244:247], v[40:43], v[120:123], v[244:247]
    s_waitcnt lgkmcnt(8)
    v_mfma_f32_16x16x32_bf16 v[148:151], v[44:47], v[60:63], v[148:151]
    ds_read_b128 v[60:63], v4 offset:0
    v_mfma_f32_16x16x32_bf16 v[148:151], v[48:51], v[92:95], v[148:151]
    ds_read_b128 v[92:95], v6 offset:0
    v_mfma_f32_16x16x32_bf16 v[164:167], v[44:47], v[64:67], v[164:167]
    ds_read_b128 v[64:67], v4 offset:4096
    v_mfma_f32_16x16x32_bf16 v[164:167], v[48:51], v[96:99], v[164:167]
    ds_read_b128 v[96:99], v6 offset:4096
    v_mfma_f32_16x16x32_bf16 v[180:183], v[44:47], v[68:71], v[180:183]
    ds_read_b128 v[68:71], v4 offset:8192
    v_mfma_f32_16x16x32_bf16 v[180:183], v[48:51], v[100:103], v[180:183]
    ds_read_b128 v[100:103], v6 offset:8192
    v_mfma_f32_16x16x32_bf16 v[196:199], v[44:47], v[72:75], v[196:199]
    ds_read_b128 v[72:75], v4 offset:12288
    v_mfma_f32_16x16x32_bf16 v[196:199], v[48:51], v[104:107], v[196:199]
    ds_read_b128 v[104:107], v6 offset:12288
    v_mfma_f32_16x16x32_bf16 v[212:215], v[44:47], v[76:79], v[212:215]
    ds_read_b128 v[76:79], v5 offset:0
    v_mfma_f32_16x16x32_bf16 v[212:215], v[48:51], v[108:111], v[212:215]
    ds_read_b128 v[108:111], v7 offset:0
    v_mfma_f32_16x16x32_bf16 v[224:227], v[44:47], v[80:83], v[224:227]
    ds_read_b128 v[80:83], v5 offset:4096
    v_mfma_f32_16x16x32_bf16 v[224:227], v[48:51], v[112:115], v[224:227]
    ds_read_b128 v[112:115], v7 offset:4096
    s_waitcnt lgkmcnt(8)
    v_mfma_f32_16x16x32_bf16 v[236:239], v[44:47], v[84:87], v[236:239]
    ds_read_b128 v[84:87], v5 offset:8192
    v_mfma_f32_16x16x32_bf16 v[236:239], v[48:51], v[116:119], v[236:239]
    ds_read_b128 v[116:119], v7 offset:8192
    v_mfma_f32_16x16x32_bf16 v[248:251], v[44:47], v[88:91], v[248:251]
    ds_read_b128 v[88:91], v5 offset:12288
    v_mfma_f32_16x16x32_bf16 v[248:251], v[48:51], v[120:123], v[248:251]
    ds_read_b128 v[120:123], v7 offset:12288
    s_branch L_loop
    .p2align 6
L_tail:
    v_perm_b32 v12, v128, v2, s28
    v_perm_b32 v13, v128, v2, s29
    v_perm_b32 v14, v128, v2, s30
    v_perm_b32 v15, v128, v2, s31
    v_perm_b32 v16, v132, v2, s28
    v_perm_b32 v17, v132, v2, s29
    v_perm_b32 v18, v132, v2, s30
    v_perm_b32 v19, v132, v2, s31
    s_waitcnt lgkmcnt(0)
    v_mfma_f32_16x16x32_bf16 v[152:155], v[52:55], v[60:63], v[152:155]
    ds_read_b32 v36, v12
    ds_read_b32 v37, v13
    ds_read_b32 v38, v14
    ds_read_b32 v39, v15
    v_mfma_f32_16x16x32_bf16 v[140:143], v[28:31], v[60:63], v[140:143]
    v_perm_b32 v12, v129, v2, s28
    v_perm_b32 v13, v129, v2, s29
    v_perm_b32 v14, v129, v2, s30
    v_perm_b32 v15, v129, v2, s31
    v_mfma_f32_16x16x32_bf16 v[204:207], v[28:31], v[76:79], v[204:207]
    ds_read_b32 v44, v16
    ds_read_b32 v45, v17
    ds_read_b32 v46, v18
    ds_read_b32 v47, v19
    v_mfma_f32_16x16x32_bf16 v[152:155], v[56:59], v[92:95], v[152:155]
    v_perm_b32 v16, v133, v2, s28
    v_perm_b32 v17, v133, v2, s29
    v_perm_b32 v18, v133, v2, s30
    v_perm_b32 v19, v133, v2, s31
    v_mfma_f32_16x16x32_bf16 v[140:143], v[32:35], v[92:95], v[140:143]
    ds_read_b32 v40, v12
    ds_read_b32 v41, v13
    ds_read_b32 v42, v14
    ds_read_b32 v43, v15
    v_mfma_f32_16x16x32_bf16 v[204:207], v[32:35], v[108:111], v[204:207]
    v_perm_b32 v12, v126, v2, s28
    v_perm_b32 v13, v126, v2, s29
    v_perm_b32 v14, v126, v2, s30
    v_perm_b32 v15, v126, v2, s31
    s_waitcnt lgkmcnt(8)
    v_mfma_f32_16x16x32_bf16 v[144:147], v[36:39], v[60:63], v[144:147]
    ds_read_b32 v48, v16
    ds_read_b32 v49, v17
    ds_read_b32 v50, v18
    ds_read_b32 v51, v19
    v_mfma_f32_16x16x32_bf16 v[208:211], v[36:39], v[76:79], v[208:211]
    v_perm_b32 v16, v130, v2, s28
    v_perm_b32 v17, v130, v2, s29
    v_perm_b32 v18, v130, v2, s30
    v_perm_b32 v19, v130, v2, s31
    s_waitcnt lgkmcnt(8)
    v_mfma_f32_16x16x32_bf16 v[148:151], v[44:47], v[60:63], v[148:151]
    ds_read_b32 v68, v12
    ds_read_b32 v69, v13
    ds_read_b32 v70, v14
    ds_read_b32 v71, v15
    v_mfma_f32_16x16x32_bf16 v[212:215], v[44:47], v[76:79], v[212:215]
    v_perm_b32 v12, v134, v2, s28
    v_perm_b32 v13, v134, v2, s29
    v_perm_b32 v14, v134, v2, s30
    v_perm_b32 v15, v134, v2, s31
    s_waitcnt lgkmcnt(8)
    v_mfma_f32_16x16x32_bf16 v[144:147], v[40:43], v[92:95], v[144:147]
    s_barrier
    ds_read_b128 v[60:63], v4 offset:49152
    ds_read_b128 v[76:79], v5 offset:49152
    ds_read_b32 v72, v16
    ds_read_b32 v73, v17
    ds_read_b32 v74, v18
    ds_read_b32 v75, v19
    v_mfma_f32_16x16x32_bf16 v[208:211], v[40:43], v[108:111], v[208:211]
    v_perm_b32 v16, v138, v2, s28
    v_perm_b32 v17, v138, v2, s29
    v_perm_b32 v18, v138, v2, s30
    v_perm_b32 v19, v138, v2, s31
    s_waitcnt lgkmcnt(8)
    v_mfma_f32_16x16x32_bf16 v[148:151], v[48:51], v[92:95], v[148:151]
    ds_read_b32 v84, v12
    ds_read_b32 v85, v13
    ds_read_b32 v86, v14
    ds_read_b32 v87, v15
    v_mfma_f32_16x16x32_bf16 v[212:215], v[48:51], v[108:111], v[212:215]
    v_perm_b32 v12, v127, v2, s28
    v_perm_b32 v13, v127, v2, s29
    v_perm_b32 v14, v127, v2, s30
    v_perm_b32 v15, v127, v2, s31
    v_mfma_f32_16x16x32_bf16 v[168:171], v[52:55], v[64:67], v[168:171]
    ds_read_b128 v[92:95], v6 offset:49152
    ds_read_b128 v[108:111], v7 offset:49152
    ds_read_b32 v88, v16
    ds_read_b32 v89, v17
    ds_read_b32 v90, v18
    ds_read_b32 v91, v19
    s_waitcnt lgkmcnt(8)
    v_mfma_f32_16x16x32_bf16 v[140:143], v[68:71], v[60:63], v[140:143]
    v_perm_b32 v16, v131, v2, s28
    v_perm_b32 v17, v131, v2, s29
    v_perm_b32 v18, v131, v2, s30
    v_perm_b32 v19, v131, v2, s31
    v_mfma_f32_16x16x32_bf16 v[204:207], v[68:71], v[76:79], v[204:207]
    ds_read_b32 v100, v12
    ds_read_b32 v101, v13
    ds_read_b32 v102, v14
    ds_read_b32 v103, v15
    v_mfma_f32_16x16x32_bf16 v[144:147], v[72:75], v[60:63], v[144:147]
    v_perm_b32 v12, v135, v2, s28
    v_perm_b32 v13, v135, v2, s29
    v_perm_b32 v14, v135, v2, s30
    v_perm_b32 v15, v135, v2, s31
    v_mfma_f32_16x16x32_bf16 v[208:211], v[72:75], v[76:79], v[208:211]
    ds_read_b32 v104, v16
    ds_read_b32 v105, v17
    ds_read_b32 v106, v18
    ds_read_b32 v107, v19
    s_waitcnt lgkmcnt(8)
    v_mfma_f32_16x16x32_bf16 v[148:151], v[84:87], v[60:63], v[148:151]
    v_perm_b32 v16, v139, v2, s28
    v_perm_b32 v17, v139, v2, s29
    v_perm_b32 v18, v139, v2, s30
    v_perm_b32 v19, v139, v2, s31
    v_mfma_f32_16x16x32_bf16 v[152:155], v[88:91], v[60:63], v[152:155]
    ds_read_b32 v116, v12
    v_mfma_f32_16x16x32_bf16 v[212:215], v[84:87], v[76:79], v[212:215]
    ds_read_b32 v117, v13
    ds_read_b32 v118, v14
    ds_read_b32 v119, v15
    ds_read_b32 v120, v16
    ds_read_b32 v121, v17
    s_waitcnt lgkmcnt(8)
    v_mfma_f32_16x16x32_bf16 v[140:143], v[100:103], v[92:95], v[140:143]
    ds_read_b32 v122, v18
    v_mfma_f32_16x16x32_bf16 v[204:207], v[100:103], v[108:111], v[204:207]
    ds_read_b32 v123, v19
    ds_read_b128 v[124:127], v25 offset:0
    ds_read_b128 v[128:131], v25 offset:16
    ds_read_b128 v[132:135], v26 offset:128
    ds_read_b128 v[136:139], v27 offset:192
    s_waitcnt lgkmcnt(8)
    v_mfma_f32_16x16x32_bf16 v[144:147], v[104:107], v[92:95], v[144:147]
    ds_read_b128 v[60:63], v4 offset:53248
    v_mfma_f32_16x16x32_bf16 v[208:211], v[104:107], v[108:111], v[208:211]
    ds_read_b128 v[76:79], v5 offset:53248
    v_mfma_f32_16x16x32_bf16 v[156:159], v[28:31], v[64:67], v[156:159]
    v_mfma_f32_16x16x32_bf16 v[216:219], v[28:31], v[80:83], v[216:219]
    v_mfma_f32_16x16x32_bf16 v[160:163], v[36:39], v[64:67], v[160:163]
    v_mfma_f32_16x16x32_bf16 v[148:151], v[116:119], v[92:95], v[148:151]
    v_mfma_f32_16x16x32_bf16 v[212:215], v[116:119], v[108:111], v[212:215]
    s_waitcnt lgkmcnt(6)
    v_mfma_f32_16x16x32_bf16 v[152:155], v[120:123], v[92:95], v[152:155]
    ds_read_b128 v[92:95], v6 offset:53248
    ds_read_b128 v[108:111], v7 offset:53248
    s_waitcnt lgkmcnt(4)
    v_mul_f32 v140, v140, v124
    v_mul_f32 v141, v141, v125
    v_mul_f32 v142, v142, v126
    v_mfma_f32_16x16x32_bf16 v[220:223], v[36:39], v[80:83], v[220:223]
    v_mul_f32 v143, v143, v127
    v_cvt_pk_bf16_f32 v140, v140, v141
    v_cvt_pk_bf16_f32 v141, v142, v143
    v_mul_f32 v204, v204, v124
    v_mul_f32 v205, v205, v125
    v_mul_f32 v206, v206, v126
    v_mfma_f32_16x16x32_bf16 v[164:167], v[44:47], v[64:67], v[164:167]
    v_mul_f32 v207, v207, v127
    v_cvt_pk_bf16_f32 v204, v204, v205
    v_cvt_pk_bf16_f32 v205, v206, v207
    v_mul_f32 v144, v144, v128
    v_mul_f32 v145, v145, v129
    v_mul_f32 v146, v146, v130
    v_mfma_f32_16x16x32_bf16 v[224:227], v[44:47], v[80:83], v[224:227]
    ds_read_b128 v[64:67], v4 offset:40960
    ds_read_b128 v[80:83], v5 offset:40960
    v_mul_f32 v147, v147, v131
    v_cvt_pk_bf16_f32 v142, v144, v145
    v_cvt_pk_bf16_f32 v143, v146, v147
    ds_write_b128 v20, v[140:143] offset:32768
    v_mfma_f32_16x16x32_bf16 v[168:171], v[56:59], v[96:99], v[168:171]
    v_mul_f32 v208, v208, v128
    v_mul_f32 v209, v209, v129
    v_mul_f32 v210, v210, v130
    v_mul_f32 v211, v211, v131
    v_cvt_pk_bf16_f32 v206, v208, v209
    v_cvt_pk_bf16_f32 v207, v210, v211
    v_mfma_f32_16x16x32_bf16 v[156:159], v[32:35], v[96:99], v[156:159]
    ds_write_b128 v21, v[204:207] offset:32768
    v_mul_f32 v148, v148, v132
    v_mul_f32 v149, v149, v133
    v_mul_f32 v150, v150, v134
    v_mul_f32 v151, v151, v135
    v_cvt_pk_bf16_f32 v148, v148, v149
    v_mfma_f32_16x16x32_bf16 v[216:219], v[32:35], v[112:115], v[216:219]
    v_cvt_pk_bf16_f32 v149, v150, v151
    ds_write_b64 v22, v[148:149] offset:32832
    v_mul_f32 v212, v212, v132
    v_mul_f32 v213, v213, v133
    v_mul_f32 v214, v214, v134
    v_mul_f32 v215, v215, v135
    v_mfma_f32_16x16x32_bf16 v[160:163], v[40:43], v[96:99], v[160:163]
    v_cvt_pk_bf16_f32 v212, v212, v213
    v_cvt_pk_bf16_f32 v213, v214, v215
    ds_write_b64 v23, v[212:213] offset:32832
    v_mul_f32 v152, v152, v136
    v_mul_f32 v153, v153, v137
    v_mul_f32 v154, v154, v138
    v_mfma_f32_16x16x32_bf16 v[220:223], v[40:43], v[112:115], v[220:223]
    v_mul_f32 v155, v155, v139
    v_cvt_pk_bf16_f32 v152, v152, v153
    v_cvt_pk_bf16_f32 v153, v154, v155
    ds_write_b64 v24, v[152:153] offset:32864
    v_mfma_f32_16x16x32_bf16 v[164:167], v[48:51], v[96:99], v[164:167]
    v_mfma_f32_16x16x32_bf16 v[224:227], v[48:51], v[112:115], v[224:227]
    ds_read_b128 v[96:99], v6 offset:40960
    s_waitcnt lgkmcnt(8)
    v_mfma_f32_16x16x32_bf16 v[168:171], v[88:91], v[60:63], v[168:171]
    ds_read_b128 v[112:115], v7 offset:40960
    v_mfma_f32_16x16x32_bf16 v[156:159], v[68:71], v[60:63], v[156:159]
    v_mfma_f32_16x16x32_bf16 v[216:219], v[68:71], v[76:79], v[216:219]
    v_mfma_f32_16x16x32_bf16 v[160:163], v[72:75], v[60:63], v[160:163]
    v_mfma_f32_16x16x32_bf16 v[220:223], v[72:75], v[76:79], v[220:223]
    s_waitcnt lgkmcnt(2)
    s_barrier
    v_mfma_f32_16x16x32_bf16 v[164:167], v[84:87], v[60:63], v[164:167]
    v_mfma_f32_16x16x32_bf16 v[224:227], v[84:87], v[76:79], v[224:227]
    ds_read_b128 v[60:63], v4 offset:57344
    v_mfma_f32_16x16x32_bf16 v[168:171], v[120:123], v[92:95], v[168:171]
    ds_read_b128 v[76:79], v5 offset:57344
    v_mfma_f32_16x16x32_bf16 v[156:159], v[100:103], v[92:95], v[156:159]
    v_mfma_f32_16x16x32_bf16 v[216:219], v[100:103], v[108:111], v[216:219]
    v_mfma_f32_16x16x32_bf16 v[160:163], v[104:107], v[92:95], v[160:163]
    v_mfma_f32_16x16x32_bf16 v[220:223], v[104:107], v[108:111], v[220:223]
    v_mfma_f32_16x16x32_bf16 v[164:167], v[116:119], v[92:95], v[164:167]
    v_mfma_f32_16x16x32_bf16 v[224:227], v[116:119], v[108:111], v[224:227]
    ds_read_b128 v[92:95], v6 offset:57344
    ds_read_b128 v[108:111], v7 offset:57344
    v_mfma_f32_16x16x32_bf16 v[184:187], v[52:55], v[64:67], v[184:187]
    v_mfma_f32_16x16x32_bf16 v[172:175], v[28:31], v[64:67], v[172:175]
    v_mul_f32 v156, v156, v124
    v_mul_f32 v157, v157, v125
    v_mul_f32 v158, v158, v126
    v_mul_f32 v159, v159, v127
    v_cvt_pk_bf16_f32 v156, v156, v157
    v_cvt_pk_bf16_f32 v157, v158, v159
    v_mfma_f32_16x16x32_bf16 v[228:231], v[28:31], v[80:83], v[228:231]
    v_mul_f32 v216, v216, v124
    v_mul_f32 v217, v217, v125
    v_mul_f32 v218, v218, v126
    v_mul_f32 v219, v219, v127
    v_cvt_pk_bf16_f32 v216, v216, v217
    v_cvt_pk_bf16_f32 v217, v218, v219
    v_mfma_f32_16x16x32_bf16 v[176:179], v[36:39], v[64:67], v[176:179]
    v_mul_f32 v160, v160, v128
    v_mul_f32 v161, v161, v129
    v_mul_f32 v162, v162, v130
    v_mul_f32 v163, v163, v131
    v_cvt_pk_bf16_f32 v158, v160, v161
    v_cvt_pk_bf16_f32 v159, v162, v163
    v_mfma_f32_16x16x32_bf16 v[232:235], v[36:39], v[80:83], v[232:235]
    ds_write_b128 v20, v[156:159] offset:47616
    v_mul_f32 v220, v220, v128
    v_mul_f32 v221, v221, v129
    v_mul_f32 v222, v222, v130
    v_mul_f32 v223, v223, v131
    v_cvt_pk_bf16_f32 v218, v220, v221
    v_mfma_f32_16x16x32_bf16 v[180:183], v[44:47], v[64:67], v[180:183]
    v_cvt_pk_bf16_f32 v219, v222, v223
    ds_write_b128 v21, v[216:219] offset:47616
    v_mul_f32 v164, v164, v132
    v_mul_f32 v165, v165, v133
    v_mul_f32 v166, v166, v134
    v_mul_f32 v167, v167, v135
    v_mfma_f32_16x16x32_bf16 v[236:239], v[44:47], v[80:83], v[236:239]
    ds_read_b128 v[64:67], v4 offset:45056
    ds_read_b128 v[80:83], v5 offset:45056
    v_cvt_pk_bf16_f32 v164, v164, v165
    v_cvt_pk_bf16_f32 v165, v166, v167
    ds_write_b64 v22, v[164:165] offset:47680
    v_mul_f32 v224, v224, v132
    s_waitcnt lgkmcnt(8)
    v_mfma_f32_16x16x32_bf16 v[184:187], v[56:59], v[96:99], v[184:187]
    v_mul_f32 v225, v225, v133
    v_mul_f32 v226, v226, v134
    v_mul_f32 v227, v227, v135
    v_cvt_pk_bf16_f32 v224, v224, v225
    v_cvt_pk_bf16_f32 v225, v226, v227
    ds_write_b64 v23, v[224:225] offset:47680
    v_mfma_f32_16x16x32_bf16 v[172:175], v[32:35], v[96:99], v[172:175]
    v_mul_f32 v168, v168, v136
    v_mul_f32 v169, v169, v137
    v_mul_f32 v170, v170, v138
    v_mul_f32 v171, v171, v139
    v_cvt_pk_bf16_f32 v168, v168, v169
    v_cvt_pk_bf16_f32 v169, v170, v171
    v_mfma_f32_16x16x32_bf16 v[228:231], v[32:35], v[112:115], v[228:231]
    ds_write_b64 v24, v[168:169] offset:47712
    v_mfma_f32_16x16x32_bf16 v[176:179], v[40:43], v[96:99], v[176:179]
    v_mfma_f32_16x16x32_bf16 v[232:235], v[40:43], v[112:115], v[232:235]
    v_mfma_f32_16x16x32_bf16 v[180:183], v[48:51], v[96:99], v[180:183]
    v_mfma_f32_16x16x32_bf16 v[236:239], v[48:51], v[112:115], v[236:239]
    ds_read_b128 v[96:99], v6 offset:45056
    s_waitcnt lgkmcnt(8)
    v_mfma_f32_16x16x32_bf16 v[184:187], v[88:91], v[60:63], v[184:187]
    ds_read_b128 v[112:115], v7 offset:45056
    v_mfma_f32_16x16x32_bf16 v[172:175], v[68:71], v[60:63], v[172:175]
    s_waitcnt lgkmcnt(2)
    s_barrier
    v_mfma_f32_16x16x32_bf16 v[228:231], v[68:71], v[76:79], v[228:231]
    v_mfma_f32_16x16x32_bf16 v[176:179], v[72:75], v[60:63], v[176:179]
    v_mfma_f32_16x16x32_bf16 v[232:235], v[72:75], v[76:79], v[232:235]
    v_mfma_f32_16x16x32_bf16 v[180:183], v[84:87], v[60:63], v[180:183]
    v_mfma_f32_16x16x32_bf16 v[236:239], v[84:87], v[76:79], v[236:239]
    ds_read_b128 v[60:63], v4 offset:61440
    v_mfma_f32_16x16x32_bf16 v[184:187], v[120:123], v[92:95], v[184:187]
    ds_read_b128 v[76:79], v5 offset:61440
    v_mfma_f32_16x16x32_bf16 v[172:175], v[100:103], v[92:95], v[172:175]
    v_mfma_f32_16x16x32_bf16 v[228:231], v[100:103], v[108:111], v[228:231]
    v_mfma_f32_16x16x32_bf16 v[176:179], v[104:107], v[92:95], v[176:179]
    v_mfma_f32_16x16x32_bf16 v[232:235], v[104:107], v[108:111], v[232:235]
    v_mfma_f32_16x16x32_bf16 v[180:183], v[116:119], v[92:95], v[180:183]
    v_mfma_f32_16x16x32_bf16 v[236:239], v[116:119], v[108:111], v[236:239]
    ds_read_b128 v[92:95], v6 offset:61440
    ds_read_b128 v[108:111], v7 offset:61440
    v_mfma_f32_16x16x32_bf16 v[200:203], v[52:55], v[64:67], v[200:203]
    v_mfma_f32_16x16x32_bf16 v[188:191], v[28:31], v[64:67], v[188:191]
    v_mul_f32 v172, v172, v124
    v_mul_f32 v173, v173, v125
    v_mul_f32 v174, v174, v126
    v_mul_f32 v175, v175, v127
    v_cvt_pk_bf16_f32 v172, v172, v173
    v_cvt_pk_bf16_f32 v173, v174, v175
    v_mfma_f32_16x16x32_bf16 v[240:243], v[28:31], v[80:83], v[240:243]
    v_mul_f32 v228, v228, v124
    v_mul_f32 v229, v229, v125
    v_mul_f32 v230, v230, v126
    v_mul_f32 v231, v231, v127
    v_cvt_pk_bf16_f32 v228, v228, v229
    v_cvt_pk_bf16_f32 v229, v230, v231
    v_mfma_f32_16x16x32_bf16 v[192:195], v[36:39], v[64:67], v[192:195]
    v_mul_f32 v176, v176, v128
    v_mul_f32 v177, v177, v129
    v_mul_f32 v178, v178, v130
    v_mul_f32 v179, v179, v131
    v_cvt_pk_bf16_f32 v174, v176, v177
    v_cvt_pk_bf16_f32 v175, v178, v179
    v_mfma_f32_16x16x32_bf16 v[244:247], v[36:39], v[80:83], v[244:247]
    ds_write_b128 v20, v[172:175] offset:0
    v_mul_f32 v232, v232, v128
    v_mul_f32 v233, v233, v129
    v_mul_f32 v234, v234, v130
    v_mul_f32 v235, v235, v131
    v_cvt_pk_bf16_f32 v230, v232, v233
    v_mfma_f32_16x16x32_bf16 v[196:199], v[44:47], v[64:67], v[196:199]
    v_cvt_pk_bf16_f32 v231, v234, v235
    ds_write_b128 v21, v[228:231] offset:0
    v_mul_f32 v180, v180, v132
    v_mul_f32 v181, v181, v133
    v_mul_f32 v182, v182, v134
    v_mul_f32 v183, v183, v135
    v_mfma_f32_16x16x32_bf16 v[248:251], v[44:47], v[80:83], v[248:251]
    v_cvt_pk_bf16_f32 v180, v180, v181
    v_cvt_pk_bf16_f32 v181, v182, v183
    ds_write_b64 v22, v[180:181] offset:64
    v_mul_f32 v236, v236, v132
    v_mul_f32 v237, v237, v133
    v_mul_f32 v238, v238, v134
    s_waitcnt lgkmcnt(7)
    v_mfma_f32_16x16x32_bf16 v[200:203], v[56:59], v[96:99], v[200:203]
    v_mul_f32 v239, v239, v135
    v_cvt_pk_bf16_f32 v236, v236, v237
    v_cvt_pk_bf16_f32 v237, v238, v239
    ds_write_b64 v23, v[236:237] offset:64
    v_mul_f32 v184, v184, v136
    v_mul_f32 v185, v185, v137
    v_mfma_f32_16x16x32_bf16 v[188:191], v[32:35], v[96:99], v[188:191]
    v_mul_f32 v186, v186, v138
    v_mul_f32 v187, v187, v139
    v_cvt_pk_bf16_f32 v184, v184, v185
    v_cvt_pk_bf16_f32 v185, v186, v187
    ds_write_b64 v24, v[184:185] offset:96
    v_mfma_f32_16x16x32_bf16 v[240:243], v[32:35], v[112:115], v[240:243]
    v_mfma_f32_16x16x32_bf16 v[192:195], v[40:43], v[96:99], v[192:195]
    v_mfma_f32_16x16x32_bf16 v[244:247], v[40:43], v[112:115], v[244:247]
    v_mfma_f32_16x16x32_bf16 v[196:199], v[48:51], v[96:99], v[196:199]
    v_mfma_f32_16x16x32_bf16 v[248:251], v[48:51], v[112:115], v[248:251]
    s_waitcnt lgkmcnt(7)
    v_mfma_f32_16x16x32_bf16 v[200:203], v[88:91], v[60:63], v[200:203]
    v_mfma_f32_16x16x32_bf16 v[188:191], v[68:71], v[60:63], v[188:191]
    s_waitcnt lgkmcnt(0)
    s_barrier
    v_mfma_f32_16x16x32_bf16 v[240:243], v[68:71], v[76:79], v[240:243]
    v_mfma_f32_16x16x32_bf16 v[192:195], v[72:75], v[60:63], v[192:195]
    v_mfma_f32_16x16x32_bf16 v[244:247], v[72:75], v[76:79], v[244:247]
    v_mfma_f32_16x16x32_bf16 v[196:199], v[84:87], v[60:63], v[196:199]
    v_mfma_f32_16x16x32_bf16 v[248:251], v[84:87], v[76:79], v[248:251]
    v_mfma_f32_16x16x32_bf16 v[200:203], v[120:123], v[92:95], v[200:203]
    v_mfma_f32_16x16x32_bf16 v[188:191], v[100:103], v[92:95], v[188:191]
    v_mfma_f32_16x16x32_bf16 v[240:243], v[100:103], v[108:111], v[240:243]
    v_mfma_f32_16x16x32_bf16 v[192:195], v[104:107], v[92:95], v[192:195]
    v_mfma_f32_16x16x32_bf16 v[244:247], v[104:107], v[108:111], v[244:247]
    v_mfma_f32_16x16x32_bf16 v[196:199], v[116:119], v[92:95], v[196:199]
    v_mfma_f32_16x16x32_bf16 v[248:251], v[116:119], v[108:111], v[248:251]
    s_nop 0
    s_nop 0
    s_nop 0
    s_nop 0
    v_mul_f32 v188, v188, v124
    v_mul_f32 v189, v189, v125
    v_mul_f32 v190, v190, v126
    v_mul_f32 v191, v191, v127
    v_cvt_pk_bf16_f32 v188, v188, v189
    v_cvt_pk_bf16_f32 v189, v190, v191
    v_mul_f32 v240, v240, v124
    v_mul_f32 v241, v241, v125
    v_mul_f32 v242, v242, v126
    v_mul_f32 v243, v243, v127
    v_cvt_pk_bf16_f32 v240, v240, v241
    v_cvt_pk_bf16_f32 v241, v242, v243
    v_mul_f32 v192, v192, v128
    v_mul_f32 v193, v193, v129
    v_mul_f32 v194, v194, v130
    v_mul_f32 v195, v195, v131
    v_cvt_pk_bf16_f32 v190, v192, v193
    v_cvt_pk_bf16_f32 v191, v194, v195
    ds_write_b128 v20, v[188:191] offset:14848
    v_mul_f32 v244, v244, v128
    v_mul_f32 v245, v245, v129
    v_mul_f32 v246, v246, v130
    v_mul_f32 v247, v247, v131
    v_cvt_pk_bf16_f32 v242, v244, v245
    v_cvt_pk_bf16_f32 v243, v246, v247
    ds_write_b128 v21, v[240:243] offset:14848
    v_mul_f32 v196, v196, v132
    v_mul_f32 v197, v197, v133
    v_mul_f32 v198, v198, v134
    v_mul_f32 v199, v199, v135
    v_cvt_pk_bf16_f32 v196, v196, v197
    v_cvt_pk_bf16_f32 v197, v198, v199
    ds_write_b64 v22, v[196:197] offset:14912
    v_mul_f32 v248, v248, v132
    v_mul_f32 v249, v249, v133
    v_mul_f32 v250, v250, v134
    v_mul_f32 v251, v251, v135
    v_cvt_pk_bf16_f32 v248, v248, v249
    v_cvt_pk_bf16_f32 v249, v250, v251
    ds_write_b64 v23, v[248:249] offset:14912
    v_mul_f32 v200, v200, v136
    v_mul_f32 v201, v201, v137
    v_mul_f32 v202, v202, v138
    v_mul_f32 v203, v203, v139
    v_cvt_pk_bf16_f32 v200, v200, v201
    v_cvt_pk_bf16_f32 v201, v202, v203
    ds_write_b64 v24, v[200:201] offset:14944
    s_waitcnt lgkmcnt(0)
    s_barrier
    s_endpgm
L_code_end:
    .p2align 12
L_packers:
    s_mov_b32 s26, 7168
    s_mov_b32 s27, 0x20000
    v_and_b32 v30, 127, v0
    s_lshl_b32 s50, s34, 5
    s_add_u32 s50, s50, 159568
    v_mov_b32 v29, s50
    v_and_b32 v31, 15, v30
    v_lshl_add_u32 v31, v31, 1, v29
    v_lshrrev_b32 v32, 4, v30
    v_lshl_add_u32 v32, v32, 1, v29
    s_lshl_b32 s50, s46, 4
    s_add_u32 s50, s50, s37
    s_add_u32 s50, s50, s54
    v_mov_b32 v13, s50
    s_waitcnt lgkmcnt(0)
    v_mov_b32 v20, s60
    v_mov_b32 v21, s61
    v_mov_b32 v22, s62
    v_mov_b32 v23, s63
    v_mov_b32 v24, s64
    v_mov_b32 v25, s65
    v_mov_b32 v26, s66
    v_mov_b32 v27, s67
    ds_write_b128 v29, v[20:23]
    ds_write_b128 v29, v[24:27] offset:16
    ds_read_u16 v34, v31
    ds_read_u16 v35, v32
    ds_read_u16 v36, v32 offset:16
    v_and_b32 v31, 7, v30
    v_lshlrev_b32 v31, 4, v31
    v_lshl_add_u32 v31, v30, 8, v31
    s_waitcnt lgkmcnt(0)
    v_lshl_or_b32 v20, v35, 16, v34
    v_lshl_or_b32 v24, v36, 16, v34
    v_mov_b32 v21, v20
    v_mov_b32 v22, v20
    v_mov_b32 v23, v20
    v_mov_b32 v25, v24
    v_mov_b32 v26, v24
    v_mov_b32 v27, v24
    v_xor_b32 v32, 0, v31
    ds_write_b128 v32, v[20:23]
    ds_write_b128 v32, v[24:27] offset:32768
    v_xor_b32 v32, 16, v31
    ds_write_b128 v32, v[20:23]
    ds_write_b128 v32, v[24:27] offset:32768
    v_xor_b32 v32, 32, v31
    ds_write_b128 v32, v[20:23]
    ds_write_b128 v32, v[24:27] offset:32768
    v_xor_b32 v32, 48, v31
    ds_write_b128 v32, v[20:23]
    ds_write_b128 v32, v[24:27] offset:32768
    v_xor_b32 v32, 64, v31
    ds_write_b128 v32, v[20:23]
    ds_write_b128 v32, v[24:27] offset:32768
    v_xor_b32 v32, 80, v31
    ds_write_b128 v32, v[20:23]
    ds_write_b128 v32, v[24:27] offset:32768
    v_xor_b32 v32, 96, v31
    ds_write_b128 v32, v[20:23]
    ds_write_b128 v32, v[24:27] offset:32768
    v_xor_b32 v32, 112, v31
    ds_write_b128 v32, v[20:23]
    ds_write_b128 v32, v[24:27] offset:32768
    s_or_b32 s50, s55, 0x30
    v_mov_b32 v12, s50
    s_lshl_b32 s50, s46, 1
    s_add_u32 s50, s50, s34
    s_waitcnt lgkmcnt(0)
    s_barrier
    s_cmp_eq_u32 s50, 7
    s_cbranch_scc1 L_A7
    s_cmp_eq_u32 s50, 8
    s_cbranch_scc1 L_B6
    s_cmp_eq_u32 s50, 9
    s_cbranch_scc1 L_B7
    s_mov_b64 exec, 1
    buffer_store_byte v12, v13, s[56:59], 0 offen
    s_mov_b64 exec, -1
    s_barrier
    s_mov_b32 s40, 4
    s_call_b64 s[84:85], L_issue
    s_call_b64 s[84:85], L_issue_b
    s_barrier
    s_call_b64 s[84:85], L_pack
    s_call_b64 s[84:85], L_pack_b
    s_call_b64 s[84:85], L_store
    s_barrier
    s_or_b32 s50, s55, 112
    v_mov_b32 v12, s50
    s_mov_b64 exec, 1
    s_waitcnt vmcnt(0)
    buffer_store_byte v12, v13, s[56:59], 0 offen
    s_mov_b64 exec, -1
    s_branch L_k_fin
L_A7:
    s_barrier
    s_barrier
    s_barrier
    s_mov_b32 s40, 6
    s_call_b64 s[84:85], L_issue
    s_call_b64 s[84:85], L_issue_b
    s_barrier
    s_call_b64 s[84:85], L_pack
    s_call_b64 s[84:85], L_pack_b
    s_call_b64 s[84:85], L_store
    s_barrier
    s_barrier
    s_or_b32 s50, s55, 240
    v_mov_b32 v12, s50
    s_mov_b64 exec, 1
    s_waitcnt vmcnt(0)
    buffer_store_byte v12, v13, s[56:59], 0 offen
    s_mov_b64 exec, -1
    s_branch L_k_fin
L_B6:
    s_call_b64 s[84:85], L_pack
    s_call_b64 s[84:85], L_pack_b
    s_call_b64 s[84:85], L_store
    s_or_b32 s50, s55, 16
    v_mov_b32 v12, s50
    s_mov_b64 exec, 1
    s_waitcnt vmcnt(0)
    buffer_store_byte v12, v13, s[56:59], 0 offen
    s_mov_b64 exec, -1
    s_barrier
    s_mov_b32 s40, 5
    s_call_b64 s[84:85], L_issue
    s_call_b64 s[84:85], L_issue_b
    s_barrier
    s_call_b64 s[84:85], L_pack
    s_call_b64 s[84:85], L_pack_b
    s_call_b64 s[84:85], L_store
    s_barrier
    s_or_b32 s50, s55, 112
    v_mov_b32 v12, s50
    s_mov_b64 exec, 1
    s_waitcnt vmcnt(0)
    buffer_store_byte v12, v13, s[56:59], 0 offen
    s_mov_b64 exec, -1
    s_branch L_k_fin
L_B7:
    s_call_b64 s[84:85], L_pack
    s_call_b64 s[84:85], L_pack_b
    s_call_b64 s[84:85], L_store
    s_barrier
    s_or_b32 s50, s55, 48
    v_mov_b32 v12, s50
    s_mov_b64 exec, 1
    s_waitcnt vmcnt(0)
    buffer_store_byte v12, v13, s[56:59], 0 offen
    s_mov_b64 exec, -1
    s_barrier
    s_barrier
    s_barrier
    s_barrier
    s_mov_b32 s40, 7
    s_call_b64 s[84:85], L_issue
    s_barrier
    s_call_b64 s[84:85], L_issue_b
    s_barrier
    s_call_b64 s[84:85], L_pack
    s_barrier
    s_call_b64 s[84:85], L_pack_b
    s_call_b64 s[84:85], L_store
    s_barrier
    s_or_b32 s50, s55, 240
    v_mov_b32 v12, s50
    s_mov_b64 exec, 1
    s_waitcnt vmcnt(0)
    buffer_store_byte v12, v13, s[56:59], 0 offen
    s_mov_b64 exec, -1
    s_branch L_k_fin
L_k_fin:
    v_lshlrev_b32 v33, 2, v30
    s_mul_i32 s50, s38, 448
    buffer_load_dword v37, v33, s[24:27], s50 offen
    v_lshlrev_b32 v33, 3, v30
    v_add_u32 v33, 159760, v33
    v_cmp_gt_u32 vcc, 112, v30
    s_barrier
    s_barrier
    s_waitcnt vmcnt(0)
    v_lshlrev_b32 v38, 16, v37
    v_and_b32 v39, 0xffff0000, v37
    s_mov_b64 exec, vcc
    ds_write_b64 v33, v[38:39]
    s_waitcnt lgkmcnt(0)
    s_endpgm
L_selfpack:
    s_mov_b32 s53, 0
    s_mov_b32 s43, s38
L_sp_loop:
    s_lshr_b32 s40, s53, 3
    s_bfe_u32 s41, s53, 0x20001
    s_and_b32 s42, s53, 1
    s_call_b64 s[84:85], L_issue
    s_call_b64 s[84:85], L_issue_b
    s_call_b64 s[84:85], L_pack
    s_call_b64 s[84:85], L_pack_b
    s_call_b64 s[84:85], L_store
    s_add_u32 s53, s53, 1
    s_cmp_lt_u32 s53, 64
    s_cbranch_scc1 L_sp_loop
    s_waitcnt vmcnt(0)
    s_mov_b32 s79, 0
    v_mov_b32 v14, 159744
    v_mov_b32 v15, 1
    ds_write_b32 v14, v15
    s_branch L_poll_ok
.section .rodata,"a"
.p2align 6
.amdhsa_kernel standalone__normalfloat_lut_codebook_lookup__prompt_kernel
  .amdhsa_next_free_vgpr 252
  .amdhsa_next_free_sgpr 102
  .amdhsa_accum_offset 252
  .amdhsa_group_segment_fixed_size 0
  .amdhsa_kernarg_size 56
  .amdhsa_float_denorm_mode_32 3
  .amdhsa_user_sgpr_count 2
  .amdhsa_user_sgpr_kernarg_segment_ptr 1
  .amdhsa_system_sgpr_workgroup_id_x 1
.end_amdhsa_kernel
```
